```python
import torch

def _softmax(x, axis=-1):
    return torch.softmax(x, dim=axis)

def _gelu(x):
    return torch.nn.functional.gelu(x, approximate='tanh')

def _silu(x):
    return torch.nn.functional.silu(x)

def _sigmoid(x):
    return torch.sigmoid(x)

def _layernorm(x, axis=-1, eps=1e-05):
    m = x.mean(dim=axis, keepdim=True)
    v = x.var(dim=axis, keepdim=True, unbiased=False)
    return (x - m) / torch.sqrt(v + eps)

def _scatter_add(tgt, idx, src, axis=0):
    return tgt.clone().index_add_(axis, idx, src)

def _segment_sum(src, seg, n):
    out = torch.zeros((n,) + src.shape[1:], dtype=src.dtype)
    return out.index_add_(0, seg, src)

def _pad(x, pw):
    flat = tuple((v for pair in reversed(pw) for v in pair))
    return torch.nn.functional.pad(x, flat)
kernel_name = 'adaLN_cond__ssm_conv_h3__mixer_gmlp__prompt'

def setup_inputs():

    _w = lambda a: (lambda t: t.to(torch.bfloat16) if t.is_floating_point() else t)(torch.as_tensor(a))

    def _A_setup():
        B, S, D = (1, 2048, 1024)
        ks = 4
        return {'q': _w((lambda *s: torch.randn(*s, dtype=torch.bfloat16) * 0.05)(B, S, D)), 'k': _w((lambda *s: torch.randn(*s, dtype=torch.bfloat16) * 0.8)(B, S, D)), 'v': _w((lambda *s: torch.randn(*s, dtype=torch.bfloat16) * 0.8)(B, S, D)), 'shift_k': _w((lambda *s: torch.randn(*s, dtype=torch.bfloat16) * 0.8)(D, ks) * 0.5), 'ssm_k': _w((lambda *s: torch.randn(*s, dtype=torch.bfloat16) * 0.8)(D, S) * (1.0 / S ** 0.5)), 'ssm_D': _w((lambda *s: torch.randn(*s, dtype=torch.bfloat16) * 0.8)(D))}
    _A_in = _A_setup()

    def _B_setup():
        B, S, D, F = (1, 2048, 1024, 3584)
        Fh = F // 2
        return {'x': _w((lambda *s: torch.randn(*s, dtype=torch.bfloat16) * 0.05)(B, S, D)), 'w_in': _w((lambda *s: torch.randn(*s, dtype=torch.bfloat16) * 0.4)(D, 2 * Fh)), 'w_sp': _w(0.01 * (lambda *s: torch.randn(*s, dtype=torch.bfloat16) * 0.4)(S, S)), 'b_sp': _w(1.0 + 0.01 * (lambda *s: torch.randn(*s, dtype=torch.bfloat16) * 0.05)(S)), 'w_out': _w((lambda *s: torch.randn(*s, dtype=torch.bfloat16) * 0.05)(Fh, D))}
    _B_in = _B_setup()
    return {'A_q': _A_in['q'], 'A_k': _A_in['k'], 'A_v': _A_in['v'], 'A_shift_k': _A_in['shift_k'], 'A_ssm_k': _A_in['ssm_k'], 'A_ssm_D': _A_in['ssm_D'], 'B_x': _B_in['x'], 'B_w_in': _B_in['w_in'], 'B_w_sp': _B_in['w_sp'], 'B_b_sp': _B_in['b_sp'], 'B_w_out': _B_in['w_out'], 'c': _w((lambda *s: torch.randn(*s, dtype=torch.bfloat16) * 0.1)(1, 1024) * 8.0), 'w_mod': _w((lambda *s: torch.randn(*s, dtype=torch.bfloat16) * 0.1)(1024, 6 * 1024) * 1024 ** (-0.5) * 8.0)}

def reference(A_q, A_k, A_v, A_shift_k, A_ssm_k, A_ssm_D, B_x, B_w_in, B_w_sp, B_b_sp, B_w_out, c, w_mod):

    def _A_ref(q, k, v, shift_k, ssm_k, ssm_D):
        B, S, D = q.shape
        ks = shift_k.shape[-1]
        k_pad = _pad(k, ((0, 0), (ks - 1, 0), (0, 0)))
        k_shift = torch.zeros_like(k)
        for t in range(ks):
            k_shift = k_shift + k_pad[:, t:t + S, :] * shift_k[:, ks - 1 - t][None, None, :]
        kv = k_shift * v
        L = 2 * S
        kv_pad = _pad(kv, ((0, 0), (0, S), (0, 0)))
        kf_pad = _pad(ssm_k, ((0, 0), (0, S)))
        kv_f = (lambda x, axes=(-2, -1): torch.fft.rfft2(x.float(), dim=axes))(kv_pad[:, None, :, :], axes=(1, 2))
        kf_f = (lambda x, axes=(-2, -1): torch.fft.rfft2(x.float(), dim=axes))(kf_pad[:, None, :], axes=(1, 2))
        kf_f = (lambda x, *d: x.permute(*d))(kf_f, 1, 2, 0)
        y_f = kv_f * kf_f[None, :, :, :]
        y = (lambda x, s, axes=(-2, -1): torch.fft.irfft2(x, s=s, dim=axes).to(torch.bfloat16))(y_f, (1, L), axes=(1, 2))[:, 0, :S, :]
        y = y + kv * ssm_D[None, None, :]
        return q * y

    def _B_ref(x, w_in, w_sp, b_sp, w_out):
        B, S, D = x.shape
        F = w_in.shape[-1]
        Fh = F // 2
        z = _gelu(torch.einsum('bsd,df->bsf', x, w_in))
        z1 = z[..., :Fh].clone()
        z2 = _layernorm(z[..., Fh:], axis=-1)
        g = torch.einsum('ts,bsf->btf', w_sp, z2) + b_sp[None, :, None]
        return torch.einsum('bsf,fd->bsd', z1 * g, w_out)
    x = A_q
    mod = (_silu(c) @ w_mod).reshape(c.shape[0], 6, 1, -1)
    sa, ca, ga, sb, cb, gb = (mod[:, 0].clone(), mod[:, 1].clone(), mod[:, 2].clone(), mod[:, 3].clone(), mod[:, 4].clone(), mod[:, 5].clone())
    h = _layernorm(x, axis=-1) * (1 + ca) + sa
    x = x + ga * _A_ref(h, A_k, A_v, A_shift_k, A_ssm_k, A_ssm_D)
    h = _layernorm(x, axis=-1) * (1 + cb) + sb
    x = x + gb * _B_ref(h, B_w_in, B_w_sp, B_b_sp, B_w_out)
    return x
```

```asm
; @launch grid=(256,1,1) block=(512,1,1) lds=163840
.amdgcn_target "amdgcn-amd-amdhsa--gfx950"
.text
.globl adaLN_cond__ssm_conv_h3__mixer_gmlp__prompt_kernel
.p2align 8
.type adaLN_cond__ssm_conv_h3__mixer_gmlp__prompt_kernel,@function
adaLN_cond__ssm_conv_h3__mixer_gmlp__prompt_kernel:
    s_load_dwordx16 s[64:79], s[0:1], 0
    s_load_dwordx16 s[80:95], s[0:1], 64
    s_cmp_ge_u32 s2, 256
    s_cbranch_scc1 L_m_end
    s_getpc_b64 s[96:97]
L_m_pc0:
    s_lshr_b32 s3, s2, 3
    s_mul_i32 s3, s3, 1536
    v_lshl_add_u32 v4, v0, 7, s3
    v_min_u32 v4, L_m_end-L_m_pc0-4, v4
    v_mov_b32 v5, s97
    v_add_co_u32 v4, vcc, s96, v4
    s_nop 1
    v_addc_co_u32 v5, vcc, 0, v5, vcc
    v_cmp_gt_u32 vcc, 12, v0
    s_and_saveexec_b64 s[4:5], vcc
    s_cbranch_execz L_m_ncp1
    global_load_dword v249, v[4:5], off
L_m_ncp1:
    s_mov_b64 exec, -1
    v_lshrrev_b32 v2, 6, v0
    v_and_b32 v1, 63, v0
    s_and_b32 s16, s2, 7
    s_lshr_b32 s17, s2, 3
    v_readfirstlane_b32 s18, v2
    s_lshr_b32 s12, s16, 1
    s_lshl_b32 s12, s12, 2
    s_and_b32 s3, s17, 3
    s_add_u32 s12, s12, s3
    s_and_b32 s19, s16, 1
    s_lshr_b32 s3, s17, 2
    s_mul_i32 s13, s19, 7
    s_add_u32 s13, s13, s3
    s_lshl_b32 s14, s19, 3
    s_add_u32 s14, s14, s3
    s_mov_b32 s97, s2
    s_cmp_ge_u32 s18, 4
    s_cbranch_scc1 L_m_prod
    v_and_b32 v3, 31, v0
    v_lshrrev_b32 v17, 5, v0
    s_lshl_b32 s19, s17, 17
    s_lshl_b32 s3, s16, 8
    s_add_u32 s19, s19, s3
    s_sub_u32 s19, s19, 6144
    v_lshlrev_b32 v4, 14, v17
    v_lshl_add_u32 v4, v3, 3, v4
    v_add_u32 v4, s19, v4
    s_lshl_b32 s3, s16, 10
    v_lshl_add_u32 v15, v3, 5, s3
    v_add_u32 v5, 2048, v4
    v_add_u32 v6, 4096, v4
    v_add_u32 v7, 6144, v4
    v_add_u32 v8, 8192, v4
    v_add_u32 v9, 10240, v4
    v_add_u32 v10, 12288, v4
    v_add_u32 v11, 14336, v4
    v_add_u32 v12, 16384, v4
    v_add_u32 v13, 18432, v4
    v_add_u32 v14, 20480, v4
    s_waitcnt lgkmcnt(0)
    s_mov_b32 s20, s66
    s_mov_b32 s21, s67
    s_mov_b32 s22, 4194304
    s_mov_b32 s23, 0x20000
    buffer_load_dwordx2 v[18:19], v4, s[20:23], 0 offen
    buffer_load_dwordx2 v[20:21], v5, s[20:23], 0 offen
    buffer_load_dwordx2 v[22:23], v6, s[20:23], 0 offen
    buffer_load_dwordx2 v[24:25], v7, s[20:23], 0 offen
    buffer_load_dwordx2 v[26:27], v8, s[20:23], 0 offen
    buffer_load_dwordx2 v[28:29], v9, s[20:23], 0 offen
    buffer_load_dwordx2 v[30:31], v10, s[20:23], 0 offen
    buffer_load_dwordx2 v[32:33], v11, s[20:23], 0 offen
    buffer_load_dwordx2 v[34:35], v12, s[20:23], 0 offen
    buffer_load_dwordx2 v[36:37], v13, s[20:23], 0 offen
    buffer_load_dwordx2 v[38:39], v14, s[20:23], 0 offen
    s_mov_b32 s28, s70
    s_mov_b32 s29, s71
    s_mov_b32 s30, 8192
    s_mov_b32 s31, 0x20000
    buffer_load_dwordx4 v[56:59], v15, s[28:31], 0 offen
    buffer_load_dwordx4 v[60:63], v15, s[28:31], 0 offen offset:16
    s_mov_b32 s24, s68
    s_mov_b32 s25, s69
    s_mov_b32 s26, 4194304
    s_mov_b32 s27, 0x20000
    buffer_load_dwordx2 v[40:41], v7, s[24:27], 0 offen
    buffer_load_dwordx2 v[42:43], v8, s[24:27], 0 offen
    buffer_load_dwordx2 v[44:45], v9, s[24:27], 0 offen
    buffer_load_dwordx2 v[46:47], v10, s[24:27], 0 offen
    buffer_load_dwordx2 v[48:49], v11, s[24:27], 0 offen
    buffer_load_dwordx2 v[50:51], v12, s[24:27], 0 offen
    buffer_load_dwordx2 v[52:53], v13, s[24:27], 0 offen
    buffer_load_dwordx2 v[54:55], v14, s[24:27], 0 offen
    v_mov_b32 v2, 274432
    s_add_u32 s44, s94, 9175040
    s_addc_u32 s45, s95, 0
    s_mov_b32 s46, 509952
    s_mov_b32 s47, 0x20000
    buffer_load_dword v2, v2, s[44:47], 0 offen sc1
    s_mov_b32 s32, s94
    s_mov_b32 s33, s95
    s_mov_b32 s34, 4194304
    s_mov_b32 s35, 0x20000
    s_mov_b32 s36, s74
    s_mov_b32 s37, s75
    s_mov_b32 s38, 2048
    s_mov_b32 s39, 0x20000
    s_add_u32 s40, s94, 12582912
    s_addc_u32 s41, s95, 0
    s_mov_b32 s42, 4194304
    s_mov_b32 s43, 0x20000
    s_lshl_b32 s48, s16, 7
    s_lshl_b32 s3, s17, 2
    s_add_u32 s48, s48, s3
    s_add_u32 s49, s48, s18
    s_lshl_b32 s3, s49, 1
    v_mov_b32 v226, s3
    buffer_load_ushort v240, v226, s[36:39], 0 offen
    s_barrier
    v_sub_u32 v230, 7, v17
    v_and_b32 v231, 7, v3
    v_xor_b32 v230, v230, v231
    v_lshlrev_b32 v230, 4, v230
    v_lshl_add_u32 v230, v3, 9, v230
    v_add_u32 v230, 65536, v230
    v_lshrrev_b32 v233, 3, v0
    v_and_b32 v231, 7, v0
    v_lshrrev_b32 v232, 2, v233
    v_xor_b32 v232, v232, v231
    v_lshlrev_b32 v232, 4, v232
    v_lshl_add_u32 v232, v233, 7, v232
    v_add_u32 v232, 65536, v232
    s_lshl_b32 s3, s16, 19
    s_lshl_b32 s19, s17, 7
    s_sub_u32 s3, s3, s19
    s_add_u32 s3, s3, 3968
    v_lshlrev_b32 v231, 4, v231
    v_lshl_add_u32 v231, v233, 12, v231
    v_add_u32 v231, s3, v231
    v_mov_b32 v242, 0
    s_mov_b32 s53, 1
L_m_p12:
    s_cmp_eq_u32 s53, 0
    s_cbranch_scc1 L_m_w4
    s_waitcnt vmcnt(12)
L_m_w4:
    v_lshlrev_b32 v128, 16, v18
    v_and_b32 v129, 0xffff0000, v18
    v_lshlrev_b32 v130, 16, v19
    v_and_b32 v131, 0xffff0000, v19
    v_lshlrev_b32 v132, 16, v20
    v_and_b32 v133, 0xffff0000, v20
    v_lshlrev_b32 v134, 16, v21
    v_and_b32 v135, 0xffff0000, v21
    v_lshlrev_b32 v136, 16, v22
    v_and_b32 v137, 0xffff0000, v22
    v_lshlrev_b32 v138, 16, v23
    v_and_b32 v139, 0xffff0000, v23
    v_lshlrev_b32 v140, 16, v24
    v_and_b32 v141, 0xffff0000, v24
    v_lshlrev_b32 v142, 16, v25
    v_and_b32 v143, 0xffff0000, v25
    v_lshlrev_b32 v144, 16, v26
    v_and_b32 v145, 0xffff0000, v26
    v_lshlrev_b32 v146, 16, v27
    v_and_b32 v147, 0xffff0000, v27
    v_lshlrev_b32 v148, 16, v28
    v_and_b32 v149, 0xffff0000, v28
    v_lshlrev_b32 v150, 16, v29
    v_and_b32 v151, 0xffff0000, v29
    v_lshlrev_b32 v152, 16, v30
    v_and_b32 v153, 0xffff0000, v30
    v_lshlrev_b32 v154, 16, v31
    v_and_b32 v155, 0xffff0000, v31
    v_lshlrev_b32 v156, 16, v32
    v_and_b32 v157, 0xffff0000, v32
    v_lshlrev_b32 v158, 16, v33
    v_and_b32 v159, 0xffff0000, v33
    v_lshlrev_b32 v160, 16, v34
    v_and_b32 v161, 0xffff0000, v34
    v_lshlrev_b32 v162, 16, v35
    v_and_b32 v163, 0xffff0000, v35
    v_lshlrev_b32 v164, 16, v36
    v_and_b32 v165, 0xffff0000, v36
    v_lshlrev_b32 v166, 16, v37
    v_and_b32 v167, 0xffff0000, v37
    v_lshlrev_b32 v168, 16, v38
    v_and_b32 v169, 0xffff0000, v38
    v_lshlrev_b32 v170, 16, v39
    v_and_b32 v171, 0xffff0000, v39
    s_cbranch_scc1 L_m_w5
    s_waitcnt vmcnt(10)
L_m_w5:
    v_lshlrev_b32 v172, 16, v56
    v_and_b32 v176, 0xffff0000, v56
    v_lshlrev_b32 v180, 16, v57
    v_and_b32 v184, 0xffff0000, v57
    v_lshlrev_b32 v173, 16, v58
    v_and_b32 v177, 0xffff0000, v58
    v_lshlrev_b32 v181, 16, v59
    v_and_b32 v185, 0xffff0000, v59
    v_lshlrev_b32 v174, 16, v60
    v_and_b32 v178, 0xffff0000, v60
    v_lshlrev_b32 v182, 16, v61
    v_and_b32 v186, 0xffff0000, v61
    v_lshlrev_b32 v175, 16, v62
    v_and_b32 v179, 0xffff0000, v62
    v_lshlrev_b32 v183, 16, v63
    v_and_b32 v187, 0xffff0000, v63
    v_pk_mul_f32 v[188:189], v[128:129], v[184:185]
    v_pk_fma_f32 v[188:189], v[132:133], v[180:181], v[188:189]
    v_pk_fma_f32 v[188:189], v[136:137], v[176:177], v[188:189]
    v_pk_fma_f32 v[188:189], v[140:141], v[172:173], v[188:189]
    v_pk_mul_f32 v[190:191], v[130:131], v[186:187]
    v_pk_fma_f32 v[190:191], v[134:135], v[182:183], v[190:191]
    v_pk_fma_f32 v[190:191], v[138:139], v[178:179], v[190:191]
    v_pk_fma_f32 v[190:191], v[142:143], v[174:175], v[190:191]
    v_pk_mul_f32 v[192:193], v[132:133], v[184:185]
    v_pk_fma_f32 v[192:193], v[136:137], v[180:181], v[192:193]
    v_pk_fma_f32 v[192:193], v[140:141], v[176:177], v[192:193]
    v_pk_fma_f32 v[192:193], v[144:145], v[172:173], v[192:193]
    v_pk_mul_f32 v[194:195], v[134:135], v[186:187]
    v_pk_fma_f32 v[194:195], v[138:139], v[182:183], v[194:195]
    v_pk_fma_f32 v[194:195], v[142:143], v[178:179], v[194:195]
    v_pk_fma_f32 v[194:195], v[146:147], v[174:175], v[194:195]
    v_pk_mul_f32 v[196:197], v[136:137], v[184:185]
    v_pk_fma_f32 v[196:197], v[140:141], v[180:181], v[196:197]
    v_pk_fma_f32 v[196:197], v[144:145], v[176:177], v[196:197]
    v_pk_fma_f32 v[196:197], v[148:149], v[172:173], v[196:197]
    v_pk_mul_f32 v[198:199], v[138:139], v[186:187]
    v_pk_fma_f32 v[198:199], v[142:143], v[182:183], v[198:199]
    v_pk_fma_f32 v[198:199], v[146:147], v[178:179], v[198:199]
    v_pk_fma_f32 v[198:199], v[150:151], v[174:175], v[198:199]
    v_pk_mul_f32 v[200:201], v[140:141], v[184:185]
    v_pk_fma_f32 v[200:201], v[144:145], v[180:181], v[200:201]
    v_pk_fma_f32 v[200:201], v[148:149], v[176:177], v[200:201]
    v_pk_fma_f32 v[200:201], v[152:153], v[172:173], v[200:201]
    v_pk_mul_f32 v[202:203], v[142:143], v[186:187]
    v_pk_fma_f32 v[202:203], v[146:147], v[182:183], v[202:203]
    v_pk_fma_f32 v[202:203], v[150:151], v[178:179], v[202:203]
    v_pk_fma_f32 v[202:203], v[154:155], v[174:175], v[202:203]
    v_pk_mul_f32 v[204:205], v[144:145], v[184:185]
    v_pk_fma_f32 v[204:205], v[148:149], v[180:181], v[204:205]
    v_pk_fma_f32 v[204:205], v[152:153], v[176:177], v[204:205]
    v_pk_fma_f32 v[204:205], v[156:157], v[172:173], v[204:205]
    v_pk_mul_f32 v[206:207], v[146:147], v[186:187]
    v_pk_fma_f32 v[206:207], v[150:151], v[182:183], v[206:207]
    v_pk_fma_f32 v[206:207], v[154:155], v[178:179], v[206:207]
    v_pk_fma_f32 v[206:207], v[158:159], v[174:175], v[206:207]
    v_pk_mul_f32 v[208:209], v[148:149], v[184:185]
    v_pk_fma_f32 v[208:209], v[152:153], v[180:181], v[208:209]
    v_pk_fma_f32 v[208:209], v[156:157], v[176:177], v[208:209]
    v_pk_fma_f32 v[208:209], v[160:161], v[172:173], v[208:209]
    v_pk_mul_f32 v[210:211], v[150:151], v[186:187]
    v_pk_fma_f32 v[210:211], v[154:155], v[182:183], v[210:211]
    v_pk_fma_f32 v[210:211], v[158:159], v[178:179], v[210:211]
    v_pk_fma_f32 v[210:211], v[162:163], v[174:175], v[210:211]
    v_pk_mul_f32 v[212:213], v[152:153], v[184:185]
    v_pk_fma_f32 v[212:213], v[156:157], v[180:181], v[212:213]
    v_pk_fma_f32 v[212:213], v[160:161], v[176:177], v[212:213]
    v_pk_fma_f32 v[212:213], v[164:165], v[172:173], v[212:213]
    v_pk_mul_f32 v[214:215], v[154:155], v[186:187]
    v_pk_fma_f32 v[214:215], v[158:159], v[182:183], v[214:215]
    v_pk_fma_f32 v[214:215], v[162:163], v[178:179], v[214:215]
    v_pk_fma_f32 v[214:215], v[166:167], v[174:175], v[214:215]
    v_pk_mul_f32 v[216:217], v[156:157], v[184:185]
    v_pk_fma_f32 v[216:217], v[160:161], v[180:181], v[216:217]
    v_pk_fma_f32 v[216:217], v[164:165], v[176:177], v[216:217]
    v_pk_fma_f32 v[216:217], v[168:169], v[172:173], v[216:217]
    v_pk_mul_f32 v[218:219], v[158:159], v[186:187]
    v_pk_fma_f32 v[218:219], v[162:163], v[182:183], v[218:219]
    v_pk_fma_f32 v[218:219], v[166:167], v[178:179], v[218:219]
    v_pk_fma_f32 v[218:219], v[170:171], v[174:175], v[218:219]
    s_cbranch_scc1 L_m_w6
    s_waitcnt vmcnt(1)
    v_readfirstlane_b32 s15, v2
    s_nop 0
    s_mul_i32 s15, s15, 0x9E3779B1
    s_add_u32 s15, s15, 0x7F4A7C15
    v_mov_b32 v241, s15
    s_cmp_eq_u32 s53, 0
L_m_w6:
    v_lshlrev_b32 v128, 16, v40
    v_and_b32 v129, 0xffff0000, v40
    v_lshlrev_b32 v130, 16, v41
    v_and_b32 v131, 0xffff0000, v41
    v_lshlrev_b32 v132, 16, v42
    v_and_b32 v133, 0xffff0000, v42
    v_lshlrev_b32 v134, 16, v43
    v_and_b32 v135, 0xffff0000, v43
    v_lshlrev_b32 v136, 16, v44
    v_and_b32 v137, 0xffff0000, v44
    v_lshlrev_b32 v138, 16, v45
    v_and_b32 v139, 0xffff0000, v45
    v_lshlrev_b32 v140, 16, v46
    v_and_b32 v141, 0xffff0000, v46
    v_lshlrev_b32 v142, 16, v47
    v_and_b32 v143, 0xffff0000, v47
    v_lshlrev_b32 v144, 16, v48
    v_and_b32 v145, 0xffff0000, v48
    v_lshlrev_b32 v146, 16, v49
    v_and_b32 v147, 0xffff0000, v49
    v_lshlrev_b32 v148, 16, v50
    v_and_b32 v149, 0xffff0000, v50
    v_lshlrev_b32 v150, 16, v51
    v_and_b32 v151, 0xffff0000, v51
    v_lshlrev_b32 v152, 16, v52
    v_and_b32 v153, 0xffff0000, v52
    v_lshlrev_b32 v154, 16, v53
    v_and_b32 v155, 0xffff0000, v53
    v_lshlrev_b32 v156, 16, v54
    v_and_b32 v157, 0xffff0000, v54
    v_lshlrev_b32 v158, 16, v55
    v_and_b32 v159, 0xffff0000, v55
    v_pk_mul_f32 v[188:189], v[188:189], v[128:129]
    v_pk_mul_f32 v[190:191], v[190:191], v[130:131]
    v_pk_mul_f32 v[192:193], v[192:193], v[132:133]
    v_pk_mul_f32 v[194:195], v[194:195], v[134:135]
    v_pk_mul_f32 v[196:197], v[196:197], v[136:137]
    v_pk_mul_f32 v[198:199], v[198:199], v[138:139]
    v_pk_mul_f32 v[200:201], v[200:201], v[140:141]
    v_pk_mul_f32 v[202:203], v[202:203], v[142:143]
    v_pk_mul_f32 v[204:205], v[204:205], v[144:145]
    v_pk_mul_f32 v[206:207], v[206:207], v[146:147]
    v_pk_mul_f32 v[208:209], v[208:209], v[148:149]
    v_pk_mul_f32 v[210:211], v[210:211], v[150:151]
    v_pk_mul_f32 v[212:213], v[212:213], v[152:153]
    v_pk_mul_f32 v[214:215], v[214:215], v[154:155]
    v_pk_mul_f32 v[216:217], v[216:217], v[156:157]
    v_pk_mul_f32 v[218:219], v[218:219], v[158:159]
    v_cvt_pk_bf16_f32 v96, v216, v212
    v_cvt_pk_bf16_f32 v97, v208, v204
    v_cvt_pk_bf16_f32 v98, v200, v196
    v_cvt_pk_bf16_f32 v99, v192, v188
    v_cvt_pk_bf16_f32 v100, v217, v213
    v_cvt_pk_bf16_f32 v101, v209, v205
    v_cvt_pk_bf16_f32 v102, v201, v197
    v_cvt_pk_bf16_f32 v103, v193, v189
    v_cvt_pk_bf16_f32 v104, v218, v214
    v_cvt_pk_bf16_f32 v105, v210, v206
    v_cvt_pk_bf16_f32 v106, v202, v198
    v_cvt_pk_bf16_f32 v107, v194, v190
    v_cvt_pk_bf16_f32 v108, v219, v215
    v_cvt_pk_bf16_f32 v109, v211, v207
    v_cvt_pk_bf16_f32 v110, v203, v199
    v_cvt_pk_bf16_f32 v111, v195, v191
    s_cbranch_scc0 L_m_p1e3
    s_mov_b32 s53, 1
    s_branch L_m_p12
L_m_p1e3:
    ds_write_b128 v230, v[96:99] offset:0
    ds_write_b128 v230, v[100:103] offset:128
    ds_write_b128 v230, v[104:107] offset:256
    ds_write_b128 v230, v[108:111] offset:384
    s_waitcnt lgkmcnt(0)
    s_barrier
    ds_read_b128 v[40:43], v232 offset:0
    ds_read_b128 v[44:47], v232 offset:4096
    ds_read_b128 v[48:51], v232 offset:8192
    ds_read_b128 v[52:55], v232 offset:12288
    s_mov_b32 s3, 0
    s_waitcnt lgkmcnt(3)
    buffer_store_dwordx4 v[40:43], v231, s[32:35], s3 offen sc1
    s_mov_b32 s3, 131072
    s_waitcnt lgkmcnt(2)
    buffer_store_dwordx4 v[44:47], v231, s[32:35], s3 offen sc1
    s_mov_b32 s3, 262144
    s_waitcnt lgkmcnt(1)
    buffer_store_dwordx4 v[48:51], v231, s[32:35], s3 offen sc1
    s_mov_b32 s3, 393216
    s_waitcnt lgkmcnt(0)
    buffer_store_dwordx4 v[52:55], v231, s[32:35], s3 offen sc1
    s_mul_i32 s50, s18, 12928
    v_and_b32 v244, 15, v1
    v_lshrrev_b32 v245, 4, v1
    v_and_b32 v246, 4, v244
    v_lshlrev_b32 v246, 1, v246
    v_lshrrev_b32 v247, 3, v244
    v_lshl_add_u32 v246, v247, 2, v246
    v_and_b32 v247, 3, v244
    v_add3_u32 v246, v246, v247, 1
    v_and_b32 v247, 1, v246
    v_mul_u32_u24 v247, 4160, v247
    v_and_b32 v246, 30, v246
    v_lshl_add_u32 v247, v246, 1, v247
    v_lshl_add_u32 v247, v245, 4, v247
    s_add_u32 s3, s50, 4608
    v_add_u32 v112, s3, v247
    v_add_u32 v113, 1024, v112
    v_add_u32 v114, 2048, v112
    v_add_u32 v115, 3072, v112
    v_lshlrev_b32 v247, 5, v244
    v_sub_u32 v247, 480, v247
    v_lshl_add_u32 v247, v245, 4, v247
    v_add_u32 v116, s50, v247
    v_and_b32 v246, 1, v245
    v_lshlrev_b32 v246, 4, v246
    v_lshrrev_b32 v247, 1, v245
    v_lshl_add_u32 v246, v247, 3, v246
    v_lshl_add_u32 v246, v244, 5, v246
    v_sub_u32 v246, 504, v246
    v_add_u32 v117, s50, v246
    v_and_b32 v246, 1, v245
    v_lshl_add_u32 v246, v244, 1, v246
    v_lshl_add_u32 v246, v247, 5, v246
    v_lshlrev_b32 v246, 2, v246
    v_add_u32 v246, s18, v246
    v_and_b32 v247, 7, v244
    v_xor_b32 v246, v246, v247
    v_lshlrev_b32 v246, 4, v246
    v_add_u32 v118, 65536, v246
    v_bfe_u32 v246, v0, 3, 3
    v_xor_b32 v246, v246, v0
    v_lshlrev_b32 v246, 4, v246
    v_add_u32 v120, 65536, v246
    v_lshrrev_b32 v246, 2, v0
    v_lshlrev_b32 v246, 14, v246
    v_and_b32 v247, 3, v0
    v_lshl_add_u32 v246, v247, 4, v246
    s_lshl_b32 s3, s48, 4
    v_add_u32 v119, s3, v246
    v_and_b32 v246, 31, v1
    v_lshlrev_b32 v121, 7, v246
    v_lshlrev_b32 v122, 4, v1
    v_and_b32 v246, 4, v244
    v_lshlrev_b32 v246, 1, v246
    v_lshrrev_b32 v247, 3, v244
    v_lshl_add_u32 v246, v247, 2, v246
    v_and_b32 v247, 3, v244
    v_add_u32 v246, v246, v247
    v_lshl_add_u32 v246, v245, 3, v246
    v_sub_u32 v246, 15, v246
    s_waitcnt vmcnt(4)
    v_and_b32 v247, 1, v246
    v_lshlrev_b32 v247, 4, v247
    v_lshlrev_b32 v247, v247, v240
    v_ashrrev_i32 v246, 1, v246
    v_cmp_eq_u32 vcc, 0, v246
    s_nop 1
    v_cndmask_b32 v124, 0, v247, vcc
    v_cmp_eq_u32 vcc, 1, v246
    s_nop 1
    v_cndmask_b32 v125, 0, v247, vcc
    v_cmp_eq_u32 vcc, 2, v246
    s_nop 1
    v_cndmask_b32 v126, 0, v247, vcc
    v_cmp_eq_u32 vcc, 3, v246
    s_nop 1
    v_cndmask_b32 v127, 0, v247, vcc
    s_waitcnt vmcnt(0)
    s_barrier
    s_mul_i32 s51, s16, 4096
    s_add_u32 s51, s51, 327680
    s_cmp_lg_u32 s18, 0
    s_cbranch_scc1 L_m_nf7
    s_lshl_b32 s3, s17, 7
    s_add_u32 s3, s3, s51
    s_mov_b64 s[10:11], exec
    s_mov_b64 exec, 1
    buffer_store_dword v241, v242, s[44:47], s3 offen sc1
    s_mov_b64 exec, s[10:11]
L_m_nf7:
    v_mov_b32 v244, 151884
    s_cmp_lg_u32 s18, 0
    s_cbranch_scc1 L_m_ot8
    s_mov_b32 s11, 0
    s_mov_b32 exec_lo, 0xffffffff
    s_mov_b32 exec_hi, 0
L_m_pl11:
    buffer_load_dword v246, v121, s[44:47], s51 offen sc1
    s_add_u32 s11, s11, 1
    s_cmp_gt_u32 s11, 131072
    s_cbranch_scc1 L_m_pk12
    s_waitcnt vmcnt(0)
    v_cmp_ne_u32 vcc, s15, v246
    s_nop 4
    s_cbranch_vccnz L_m_pl11
L_m_pk12:
    s_mov_b64 exec, -1
    v_mov_b32 v245, 1
    ds_write_b32 v244, v245
    s_branch L_m_dn9
L_m_ot8:
    s_mov_b32 s11, 0
L_m_lw10:
    ds_read_b32 v245, v244
    s_add_u32 s11, s11, 1
    s_cmp_gt_u32 s11, 2097152
    s_cbranch_scc1 L_m_dn9
    s_waitcnt lgkmcnt(0)
    v_readfirstlane_b32 s10, v245
    s_sleep 1
    s_cmp_eq_u32 s10, 0
    s_cbranch_scc1 L_m_lw10
L_m_dn9:
    s_waitcnt vmcnt(0)
    s_lshl_b32 s52, s49, 12
    s_add_u32 m0, s50, 0
    s_add_u32 s3, s52, 0
    buffer_load_dwordx4 v122, s[32:35], s3 offen sc1 lds
    s_add_u32 m0, s50, 1024
    s_add_u32 s3, s52, 1024
    buffer_load_dwordx4 v122, s[32:35], s3 offen sc1 lds
    s_add_u32 m0, s50, 2048
    s_add_u32 s3, s52, 2048
    buffer_load_dwordx4 v122, s[32:35], s3 offen sc1 lds
    s_add_u32 m0, s50, 3072
    s_add_u32 s3, s52, 3072
    buffer_load_dwordx4 v122, s[32:35], s3 offen sc1 lds
    v_mov_b32 v244, 151900
    v_mov_b32 v245, 1
    s_mov_b64 exec, 1
    ds_add_u32 v244, v245
    s_mov_b64 exec, -1
    s_cmp_lg_u32 s2, 16
    s_cbranch_scc1 L_m_nc13
    s_cmp_lg_u32 s18, 0
    s_cbranch_scc1 L_m_nc13
    s_lshl_b32 s3, s2, 7
    s_add_u32 s3, s3, 294912
    s_mov_b64 s[10:11], exec
    s_mov_b64 exec, 1
    buffer_store_dword v241, v242, s[44:47], s3 offen sc1
    s_mov_b64 exec, s[10:11]
L_m_nc13:
    v_mov_b32 v244, 151896
    s_mov_b32 s11, 0
L_m_lw14:
    ds_read_b32 v245, v244
    s_add_u32 s11, s11, 1
    s_cmp_gt_u32 s11, 2097152
    s_cbranch_scc1 L_m_lo15
    s_waitcnt lgkmcnt(0)
    v_readfirstlane_b32 s10, v245
    s_nop 0
    s_cmp_ge_u32 s10, 4
    s_cbranch_scc1 L_m_lo15
    s_sleep 1
    s_branch L_m_lw14
L_m_lo15:
    s_waitcnt vmcnt(0)
    ds_read2_b32 v[128:129], v112 offset0:0 offset1:1
    ds_read2_b32 v[130:131], v112 offset0:2 offset1:3
    ds_read_b128 v[192:195], v116 offset:3584
    ds_read_b128 v[196:199], v116 offset:3072
    ds_read_b128 v[200:203], v116 offset:2560
    ds_read_b128 v[204:207], v116 offset:2048
    ds_read_b128 v[208:211], v116 offset:1536
    ds_read_b128 v[212:215], v116 offset:1024
    ds_read_b128 v[216:219], v116 offset:512
    ds_read_b128 v[220:223], v116 offset:0
    ds_read2_b32 v[132:133], v112 offset0:128 offset1:129
    ds_read2_b32 v[134:135], v112 offset0:130 offset1:131
    ds_read2_b32 v[136:137], v113 offset0:0 offset1:1
    ds_read2_b32 v[138:139], v113 offset0:2 offset1:3
    ds_read2_b32 v[140:141], v113 offset0:128 offset1:129
    ds_read2_b32 v[142:143], v113 offset0:130 offset1:131
    ds_read2_b32 v[144:145], v114 offset0:0 offset1:1
    ds_read2_b32 v[146:147], v114 offset0:2 offset1:3
    ds_read2_b32 v[148:149], v114 offset0:128 offset1:129
    ds_read2_b32 v[150:151], v114 offset0:130 offset1:131
    ds_read2_b32 v[152:153], v115 offset0:0 offset1:1
    ds_read2_b32 v[154:155], v115 offset0:2 offset1:3
    ds_read2_b32 v[156:157], v115 offset0:128 offset1:129
    ds_read2_b32 v[158:159], v115 offset0:130 offset1:131
    s_mov_b32 s53, 4
    s_waitcnt lgkmcnt(15)
    v_mfma_f32_16x16x32_bf16 v[64:67], v[124:127], v[192:195], 0
    s_waitcnt lgkmcnt(15)
    v_mfma_f32_16x16x32_bf16 v[68:71], v[124:127], v[196:199], 0
    s_waitcnt lgkmcnt(15)
    v_mfma_f32_16x16x32_bf16 v[72:75], v[124:127], v[200:203], 0
    s_waitcnt lgkmcnt(15)
    v_mfma_f32_16x16x32_bf16 v[76:79], v[124:127], v[204:207], 0
    s_waitcnt lgkmcnt(15)
    v_mfma_f32_16x16x32_bf16 v[80:83], v[124:127], v[208:211], 0
    s_waitcnt lgkmcnt(15)
    v_mfma_f32_16x16x32_bf16 v[84:87], v[124:127], v[212:215], 0
    s_waitcnt lgkmcnt(15)
    v_mfma_f32_16x16x32_bf16 v[88:91], v[124:127], v[216:219], 0
    s_waitcnt lgkmcnt(14)
    v_mfma_f32_16x16x32_bf16 v[92:95], v[124:127], v[220:223], 0
L_m_cv16:
    s_waitcnt lgkmcnt(0)
    v_mfma_f32_16x16x32_bf16 v[64:67], v[128:131], v[192:195], v[64:67]
    v_mfma_f32_16x16x32_bf16 v[68:71], v[128:131], v[196:199], v[68:71]
    v_mfma_f32_16x16x32_bf16 v[72:75], v[128:131], v[200:203], v[72:75]
    v_mfma_f32_16x16x32_bf16 v[76:79], v[128:131], v[204:207], v[76:79]
    v_mfma_f32_16x16x32_bf16 v[80:83], v[128:131], v[208:211], v[80:83]
    v_mfma_f32_16x16x32_bf16 v[84:87], v[128:131], v[212:215], v[84:87]
    v_mfma_f32_16x16x32_bf16 v[88:91], v[128:131], v[216:219], v[88:91]
    v_mfma_f32_16x16x32_bf16 v[92:95], v[128:131], v[220:223], v[92:95]
    v_mfma_f32_16x16x32_bf16 v[92:95], v[132:135], v[216:219], v[92:95]
    v_mfma_f32_16x16x32_bf16 v[88:91], v[132:135], v[212:215], v[88:91]
    v_mfma_f32_16x16x32_bf16 v[84:87], v[132:135], v[208:211], v[84:87]
    v_mfma_f32_16x16x32_bf16 v[80:83], v[132:135], v[204:207], v[80:83]
    v_mfma_f32_16x16x32_bf16 v[76:79], v[132:135], v[200:203], v[76:79]
    v_mfma_f32_16x16x32_bf16 v[72:75], v[132:135], v[196:199], v[72:75]
    v_mfma_f32_16x16x32_bf16 v[68:71], v[132:135], v[192:195], v[68:71]
    v_mfma_f32_16x16x32_bf16 v[72:75], v[136:139], v[192:195], v[72:75]
    v_mfma_f32_16x16x32_bf16 v[76:79], v[136:139], v[196:199], v[76:79]
    v_mfma_f32_16x16x32_bf16 v[80:83], v[136:139], v[200:203], v[80:83]
    v_mfma_f32_16x16x32_bf16 v[84:87], v[136:139], v[204:207], v[84:87]
    v_mfma_f32_16x16x32_bf16 v[88:91], v[136:139], v[208:211], v[88:91]
    v_mfma_f32_16x16x32_bf16 v[92:95], v[136:139], v[212:215], v[92:95]
    v_mfma_f32_16x16x32_bf16 v[92:95], v[140:143], v[208:211], v[92:95]
    v_mfma_f32_16x16x32_bf16 v[88:91], v[140:143], v[204:207], v[88:91]
    ds_read2_b32 v[160:161], v112 offset0:16 offset1:17
    v_mfma_f32_16x16x32_bf16 v[84:87], v[140:143], v[200:203], v[84:87]
    ds_read2_b32 v[162:163], v112 offset0:18 offset1:19
    v_mfma_f32_16x16x32_bf16 v[80:83], v[140:143], v[196:199], v[80:83]
    ds_read_b128 v[4:7], v116 offset:3648
    v_mfma_f32_16x16x32_bf16 v[76:79], v[140:143], v[192:195], v[76:79]
    ds_read_b128 v[8:11], v116 offset:3136
    v_mfma_f32_16x16x32_bf16 v[80:83], v[144:147], v[192:195], v[80:83]
    ds_read_b128 v[12:15], v116 offset:2624
    v_mfma_f32_16x16x32_bf16 v[84:87], v[144:147], v[196:199], v[84:87]
    ds_read_b128 v[16:19], v116 offset:2112
    v_mfma_f32_16x16x32_bf16 v[88:91], v[144:147], v[200:203], v[88:91]
    ds_read_b128 v[20:23], v116 offset:1600
    v_mfma_f32_16x16x32_bf16 v[92:95], v[144:147], v[204:207], v[92:95]
    ds_read_b128 v[24:27], v116 offset:1088
    v_mfma_f32_16x16x32_bf16 v[92:95], v[148:151], v[200:203], v[92:95]
    ds_read_b128 v[28:31], v116 offset:576
    v_mfma_f32_16x16x32_bf16 v[88:91], v[148:151], v[196:199], v[88:91]
    ds_read_b128 v[32:35], v116 offset:64
    v_mfma_f32_16x16x32_bf16 v[84:87], v[148:151], v[192:195], v[84:87]
    ds_read2_b32 v[164:165], v112 offset0:144 offset1:145
    v_mfma_f32_16x16x32_bf16 v[88:91], v[152:155], v[192:195], v[88:91]
    ds_read2_b32 v[166:167], v112 offset0:146 offset1:147
    v_mfma_f32_16x16x32_bf16 v[92:95], v[152:155], v[196:199], v[92:95]
    ds_read2_b32 v[168:169], v113 offset0:16 offset1:17
    v_mfma_f32_16x16x32_bf16 v[92:95], v[156:159], v[192:195], v[92:95]
    ds_read2_b32 v[170:171], v113 offset0:18 offset1:19
    ds_read2_b32 v[172:173], v113 offset0:144 offset1:145
    ds_read2_b32 v[174:175], v113 offset0:146 offset1:147
    ds_read2_b32 v[176:177], v114 offset0:16 offset1:17
    ds_read2_b32 v[178:179], v114 offset0:18 offset1:19
    ds_read2_b32 v[180:181], v114 offset0:144 offset1:145
    ds_read2_b32 v[182:183], v114 offset0:146 offset1:147
    ds_read2_b32 v[184:185], v115 offset0:16 offset1:17
    ds_read2_b32 v[186:187], v115 offset0:18 offset1:19
    ds_read2_b32 v[188:189], v115 offset0:144 offset1:145
    ds_read2_b32 v[190:191], v115 offset0:146 offset1:147
    s_waitcnt lgkmcnt(0)
    v_mfma_f32_16x16x32_bf16 v[64:67], v[160:163], v[4:7], v[64:67]
    v_mfma_f32_16x16x32_bf16 v[68:71], v[160:163], v[8:11], v[68:71]
    v_mfma_f32_16x16x32_bf16 v[72:75], v[160:163], v[12:15], v[72:75]
    v_mfma_f32_16x16x32_bf16 v[76:79], v[160:163], v[16:19], v[76:79]
    v_mfma_f32_16x16x32_bf16 v[80:83], v[160:163], v[20:23], v[80:83]
    v_mfma_f32_16x16x32_bf16 v[84:87], v[160:163], v[24:27], v[84:87]
    v_mfma_f32_16x16x32_bf16 v[88:91], v[160:163], v[28:31], v[88:91]
    v_mfma_f32_16x16x32_bf16 v[92:95], v[160:163], v[32:35], v[92:95]
    v_mfma_f32_16x16x32_bf16 v[92:95], v[164:167], v[28:31], v[92:95]
    v_mfma_f32_16x16x32_bf16 v[88:91], v[164:167], v[24:27], v[88:91]
    v_mfma_f32_16x16x32_bf16 v[84:87], v[164:167], v[20:23], v[84:87]
    v_mfma_f32_16x16x32_bf16 v[80:83], v[164:167], v[16:19], v[80:83]
    v_mfma_f32_16x16x32_bf16 v[76:79], v[164:167], v[12:15], v[76:79]
    v_mfma_f32_16x16x32_bf16 v[72:75], v[164:167], v[8:11], v[72:75]
    v_mfma_f32_16x16x32_bf16 v[68:71], v[164:167], v[4:7], v[68:71]
    v_mfma_f32_16x16x32_bf16 v[72:75], v[168:171], v[4:7], v[72:75]
    v_mfma_f32_16x16x32_bf16 v[76:79], v[168:171], v[8:11], v[76:79]
    v_mfma_f32_16x16x32_bf16 v[80:83], v[168:171], v[12:15], v[80:83]
    v_mfma_f32_16x16x32_bf16 v[84:87], v[168:171], v[16:19], v[84:87]
    v_mfma_f32_16x16x32_bf16 v[88:91], v[168:171], v[20:23], v[88:91]
    v_mfma_f32_16x16x32_bf16 v[92:95], v[168:171], v[24:27], v[92:95]
    v_mfma_f32_16x16x32_bf16 v[92:95], v[172:175], v[20:23], v[92:95]
    v_mfma_f32_16x16x32_bf16 v[88:91], v[172:175], v[16:19], v[88:91]
    ds_read2_b32 v[128:129], v112 offset0:32 offset1:33
    v_mfma_f32_16x16x32_bf16 v[84:87], v[172:175], v[12:15], v[84:87]
    ds_read2_b32 v[130:131], v112 offset0:34 offset1:35
    v_mfma_f32_16x16x32_bf16 v[80:83], v[172:175], v[8:11], v[80:83]
    ds_read_b128 v[192:195], v116 offset:3712
    v_mfma_f32_16x16x32_bf16 v[76:79], v[172:175], v[4:7], v[76:79]
    ds_read_b128 v[196:199], v116 offset:3200
    v_mfma_f32_16x16x32_bf16 v[80:83], v[176:179], v[4:7], v[80:83]
    ds_read_b128 v[200:203], v116 offset:2688
    v_mfma_f32_16x16x32_bf16 v[84:87], v[176:179], v[8:11], v[84:87]
    ds_read_b128 v[204:207], v116 offset:2176
    v_mfma_f32_16x16x32_bf16 v[88:91], v[176:179], v[12:15], v[88:91]
    ds_read_b128 v[208:211], v116 offset:1664
    v_mfma_f32_16x16x32_bf16 v[92:95], v[176:179], v[16:19], v[92:95]
    ds_read_b128 v[212:215], v116 offset:1152
    v_mfma_f32_16x16x32_bf16 v[92:95], v[180:183], v[12:15], v[92:95]
    ds_read_b128 v[216:219], v116 offset:640
    v_mfma_f32_16x16x32_bf16 v[88:91], v[180:183], v[8:11], v[88:91]
    ds_read_b128 v[220:223], v116 offset:128
    v_mfma_f32_16x16x32_bf16 v[84:87], v[180:183], v[4:7], v[84:87]
    ds_read2_b32 v[132:133], v112 offset0:160 offset1:161
    v_mfma_f32_16x16x32_bf16 v[88:91], v[184:187], v[4:7], v[88:91]
    ds_read2_b32 v[134:135], v112 offset0:162 offset1:163
    v_mfma_f32_16x16x32_bf16 v[92:95], v[184:187], v[8:11], v[92:95]
    ds_read2_b32 v[136:137], v113 offset0:32 offset1:33
    v_mfma_f32_16x16x32_bf16 v[92:95], v[188:191], v[4:7], v[92:95]
    ds_read2_b32 v[138:139], v113 offset0:34 offset1:35
    ds_read2_b32 v[140:141], v113 offset0:160 offset1:161
    ds_read2_b32 v[142:143], v113 offset0:162 offset1:163
    ds_read2_b32 v[144:145], v114 offset0:32 offset1:33
    ds_read2_b32 v[146:147], v114 offset0:34 offset1:35
    ds_read2_b32 v[148:149], v114 offset0:160 offset1:161
    ds_read2_b32 v[150:151], v114 offset0:162 offset1:163
    ds_read2_b32 v[152:153], v115 offset0:32 offset1:33
    ds_read2_b32 v[154:155], v115 offset0:34 offset1:35
    ds_read2_b32 v[156:157], v115 offset0:160 offset1:161
    ds_read2_b32 v[158:159], v115 offset0:162 offset1:163
    v_add_u32 v112, 128, v112
    v_add_u32 v113, 128, v113
    v_add_u32 v114, 128, v114
    v_add_u32 v115, 128, v115
    v_add_u32 v116, 128, v116
    s_sub_u32 s53, s53, 1
    s_cmp_lg_u32 s53, 0
    s_cbranch_scc1 L_m_cv16
    s_waitcnt lgkmcnt(0)
    s_nop 5
    v_cvt_pk_bf16_f32 v192, v64, v65
    v_cvt_pk_bf16_f32 v193, v66, v67
    v_cvt_pk_bf16_f32 v194, v68, v69
    v_cvt_pk_bf16_f32 v195, v70, v71
    v_cvt_pk_bf16_f32 v196, v72, v73
    v_cvt_pk_bf16_f32 v197, v74, v75
    v_cvt_pk_bf16_f32 v198, v76, v77
    v_cvt_pk_bf16_f32 v199, v78, v79
    v_cvt_pk_bf16_f32 v200, v80, v81
    v_cvt_pk_bf16_f32 v201, v82, v83
    v_cvt_pk_bf16_f32 v202, v84, v85
    v_cvt_pk_bf16_f32 v203, v86, v87
    v_cvt_pk_bf16_f32 v204, v88, v89
    v_cvt_pk_bf16_f32 v205, v90, v91
    v_cvt_pk_bf16_f32 v206, v92, v93
    v_cvt_pk_bf16_f32 v207, v94, v95
    s_nop 1
    v_permlane32_swap_b32 v192, v194
    v_permlane32_swap_b32 v193, v195
    ds_write_b128 v118, v[192:195] offset:0
    v_permlane32_swap_b32 v196, v198
    v_permlane32_swap_b32 v197, v199
    ds_write_b128 v118, v[196:199] offset:4096
    v_permlane32_swap_b32 v200, v202
    v_permlane32_swap_b32 v201, v203
    ds_write_b128 v118, v[200:203] offset:8192
    v_permlane32_swap_b32 v204, v206
    v_permlane32_swap_b32 v205, v207
    ds_write_b128 v118, v[204:207] offset:12288
    v_mov_b32 v244, 151880
    v_mov_b32 v245, 1
    s_waitcnt lgkmcnt(0)
    s_mov_b64 s[10:11], exec
    s_mov_b64 exec, 1
    ds_add_u32 v244, v245
    s_mov_b64 exec, s[10:11]
    s_mov_b32 s11, 0
L_m_ls17:
    ds_read_b32 v245, v244
    s_add_u32 s11, s11, 1
    s_cmp_gt_u32 s11, 1048576
    s_cbranch_scc1 L_m_lk18
    s_waitcnt lgkmcnt(0)
    v_readfirstlane_b32 s10, v245
    s_sleep 1
    s_cmp_lt_u32 s10, 4
    s_cbranch_scc1 L_m_ls17
L_m_lk18:
    ds_read_b128 v[96:99], v120 offset:0
    ds_read_b128 v[100:103], v120 offset:4096
    ds_read_b128 v[104:107], v120 offset:8192
    ds_read_b128 v[108:111], v120 offset:12288
    s_mov_b32 s3, 0
    s_waitcnt lgkmcnt(3)
    buffer_store_dwordx4 v[96:99], v119, s[40:43], s3 offen sc1
    s_mov_b32 s3, 1048576
    s_waitcnt lgkmcnt(2)
    buffer_store_dwordx4 v[100:103], v119, s[40:43], s3 offen sc1
    s_mov_b32 s3, 2097152
    s_waitcnt lgkmcnt(1)
    buffer_store_dwordx4 v[104:107], v119, s[40:43], s3 offen sc1
    s_mov_b32 s3, 3145728
    s_waitcnt lgkmcnt(0)
    buffer_store_dwordx4 v[108:111], v119, s[40:43], s3 offen sc1
    s_add_u32 s20, s94, 8912896
    s_addc_u32 s21, s95, 0
    s_mov_b32 s22, 12288
    s_mov_b32 s23, 0x20000
    s_add_u32 s24, s94, 25165824
    s_addc_u32 s25, s95, 0
    s_mov_b32 s26, 4194304
    s_mov_b32 s27, 0x20000
    s_add_u32 s28, s94, 12582912
    s_addc_u32 s29, s95, 0
    s_mov_b32 s30, 4194304
    s_mov_b32 s31, 0x20000
    v_bfe_u32 v2, v0, 2, 1
    v_lshrrev_b32 v11, 3, v0
    v_and_b32 v12, 3, v0
    v_lshl_add_u32 v3, v11, 2, v12
    s_lshl_b32 s3, s97, 14
    v_lshlrev_b32 v11, 13, v2
    v_lshl_add_u32 v11, v3, 4, v11
    v_add_u32 v4, s3, v11
    v_add_u32 v13, 4096, v4
    v_lshrrev_b32 v11, 3, v3
    v_lshlrev_b32 v11, 14, v11
    v_and_b32 v12, 7, v3
    v_lshl_add_u32 v11, v12, 4, v11
    v_lshl_add_u32 v11, v2, 9, v11
    s_lshr_b32 s3, s97, 4
    s_lshl_b32 s3, s3, 18
    s_and_b32 s19, s97, 15
    s_lshl_b32 s19, s19, 10
    s_add_u32 s3, s3, s19
    v_add_u32 v243, s3, v11
    v_lshlrev_b32 v5, 4, v3
    v_mul_u32_u24 v11, 8320, v2
    v_add3_u32 v6, v11, v5, 0
    v_add_u32 v6, 135168, v6
    v_lshlrev_b32 v11, 5, v2
    v_add_u32 v7, 151808, v11
    v_bfe_u32 v11, v3, 1, 3
    v_lshlrev_b32 v11, 4, v11
    v_lshlrev_b32 v12, 7, v3
    v_lshl_add_u32 v12, v2, 3, v12
    v_xor_b32 v16, 0, v11
    v_add_u32 v16, v12, v16
    v_xor_b32 v17, 16, v11
    v_add_u32 v17, v12, v17
    v_xor_b32 v18, 32, v11
    v_add_u32 v18, v12, v18
    v_xor_b32 v19, 48, v11
    v_add_u32 v19, v12, v19
    v_xor_b32 v20, 64, v11
    v_add_u32 v20, v12, v20
    v_xor_b32 v21, 80, v11
    v_add_u32 v21, v12, v21
    v_xor_b32 v22, 96, v11
    v_add_u32 v22, v12, v22
    v_xor_b32 v23, 112, v11
    v_add_u32 v23, v12, v23
    v_lshrrev_b32 v11, 4, v1
    v_lshlrev_b32 v11, 2, v11
    v_lshl_add_u32 v11, v2, 7, v11
    s_lshl_b32 s3, s18, 5
    s_add_u32 s3, s3, 16384
    v_add_u32 v8, s3, v11
    v_lshlrev_b32 v9, 7, v2
    v_and_b32 v11, 11, v1
    v_cmp_eq_u32 s[52:53], 0, v11
    v_lshlrev_b32 v10, 11, v1
    v_lshrrev_b32 v14, 2, v1
    v_lshlrev_b32 v14, 7, v14
    v_and_b32 v12, 3, v1
    v_lshl_add_u32 v14, v12, 4, v14
    v_mov_b32 v11, 151892
    v_mov_b32 v15, 1
    s_waitcnt vmcnt(0)
    s_mov_b64 exec, 1
    ds_add_rtn_u32 v15, v11, v15
    s_waitcnt lgkmcnt(0)
    v_readfirstlane_b32 s56, v15
    s_lshr_b32 s10, s2, 4
    s_lshl_b32 s10, s10, 7
    s_and_b32 s3, s2, 15
    s_lshl_b32 s3, s3, 2
    s_add_u32 s3, s3, s10
    s_add_u32 s3, s3, 491520
    s_cmp_lg_u32 s56, 3
    s_cbranch_scc1 L_m_na20
    s_mov_b64 exec, 0xff
    buffer_store_dword v241, v10, s[44:47], s3 offen sc1
L_m_na20:
    s_mov_b64 exec, -1
    v_mov_b32 v11, 151876
    s_mov_b32 s11, 0
L_m_lw21:
    ds_read_b32 v15, v11
    s_add_u32 s11, s11, 1
    s_cmp_gt_u32 s11, 2097152
    s_cbranch_scc1 L_m_lo22
    s_waitcnt lgkmcnt(0)
    v_readfirstlane_b32 s10, v15
    s_nop 0
    s_cmp_ge_u32 s10, 4
    s_cbranch_scc1 L_m_lo22
    s_sleep 1
    s_branch L_m_lw21
L_m_lo22:
    ds_read_b128 v[24:27], v6 offset:0
    ds_read_b128 v[28:31], v6 offset:2080
    ds_read_b128 v[32:35], v6 offset:4160
    ds_read_b128 v[36:39], v6 offset:6240
    ds_read_b128 v[192:195], v7 offset:0
    ds_read_b128 v[196:199], v7 offset:16
    s_add_u32 s54, s15, 15
    s_lshl_b32 s3, s55, 2
    s_add_u32 s3, s3, 278528
    s_lshl_b32 s55, s16, 8
    s_add_u32 s55, s55, 278528
    s_waitcnt lgkmcnt(0)
    v_lshlrev_b32 v64, 16, v24
    v_and_b32 v65, 0xffff0000, v24
    v_lshlrev_b32 v66, 16, v25
    v_and_b32 v67, 0xffff0000, v25
    v_lshlrev_b32 v68, 16, v26
    v_and_b32 v69, 0xffff0000, v26
    v_lshlrev_b32 v70, 16, v27
    v_and_b32 v71, 0xffff0000, v27
    v_lshlrev_b32 v72, 16, v28
    v_and_b32 v73, 0xffff0000, v28
    v_lshlrev_b32 v74, 16, v29
    v_and_b32 v75, 0xffff0000, v29
    v_lshlrev_b32 v76, 16, v30
    v_and_b32 v77, 0xffff0000, v30
    v_lshlrev_b32 v78, 16, v31
    v_and_b32 v79, 0xffff0000, v31
    v_lshlrev_b32 v80, 16, v32
    v_and_b32 v81, 0xffff0000, v32
    v_lshlrev_b32 v82, 16, v33
    v_and_b32 v83, 0xffff0000, v33
    v_lshlrev_b32 v84, 16, v34
    v_and_b32 v85, 0xffff0000, v34
    v_lshlrev_b32 v86, 16, v35
    v_and_b32 v87, 0xffff0000, v35
    v_lshlrev_b32 v88, 16, v36
    v_and_b32 v89, 0xffff0000, v36
    v_lshlrev_b32 v90, 16, v37
    v_and_b32 v91, 0xffff0000, v37
    v_lshlrev_b32 v92, 16, v38
    v_and_b32 v93, 0xffff0000, v38
    v_lshlrev_b32 v94, 16, v39
    v_and_b32 v95, 0xffff0000, v39
    v_pk_fma_f32 v[160:161], v[64:65], v[192:193], v[192:193] op_sel:[0,0,1] op_sel_hi:[1,0,1]
    v_pk_fma_f32 v[162:163], v[66:67], v[192:193], v[192:193] op_sel:[0,0,1] op_sel_hi:[1,0,1]
    v_pk_fma_f32 v[164:165], v[68:69], v[192:193], v[192:193] op_sel:[0,0,1] op_sel_hi:[1,0,1]
    v_pk_fma_f32 v[166:167], v[70:71], v[192:193], v[192:193] op_sel:[0,0,1] op_sel_hi:[1,0,1]
    v_pk_fma_f32 v[168:169], v[72:73], v[194:195], v[194:195] op_sel:[0,0,1] op_sel_hi:[1,0,1]
    v_pk_fma_f32 v[170:171], v[74:75], v[194:195], v[194:195] op_sel:[0,0,1] op_sel_hi:[1,0,1]
    v_pk_fma_f32 v[172:173], v[76:77], v[194:195], v[194:195] op_sel:[0,0,1] op_sel_hi:[1,0,1]
    v_pk_fma_f32 v[174:175], v[78:79], v[194:195], v[194:195] op_sel:[0,0,1] op_sel_hi:[1,0,1]
    v_pk_fma_f32 v[176:177], v[80:81], v[196:197], v[196:197] op_sel:[0,0,1] op_sel_hi:[1,0,1]
    v_pk_fma_f32 v[178:179], v[82:83], v[196:197], v[196:197] op_sel:[0,0,1] op_sel_hi:[1,0,1]
    v_pk_fma_f32 v[180:181], v[84:85], v[196:197], v[196:197] op_sel:[0,0,1] op_sel_hi:[1,0,1]
    v_pk_fma_f32 v[182:183], v[86:87], v[196:197], v[196:197] op_sel:[0,0,1] op_sel_hi:[1,0,1]
    v_pk_fma_f32 v[184:185], v[88:89], v[198:199], v[198:199] op_sel:[0,0,1] op_sel_hi:[1,0,1]
    v_pk_fma_f32 v[186:187], v[90:91], v[198:199], v[198:199] op_sel:[0,0,1] op_sel_hi:[1,0,1]
    v_pk_fma_f32 v[188:189], v[92:93], v[198:199], v[198:199] op_sel:[0,0,1] op_sel_hi:[1,0,1]
    v_pk_fma_f32 v[190:191], v[94:95], v[198:199], v[198:199] op_sel:[0,0,1] op_sel_hi:[1,0,1]
    s_cmp_lg_u32 s56, 3
    s_cbranch_scc1 L_m_nb19
    s_lshl_b32 s55, s16, 11
    s_add_u32 s55, s55, 491520
    s_mov_b32 s11, 0
L_m_bl23:
    buffer_load_dwordx4 v[40:43], v14, s[44:47], s55 offen sc1
    s_add_u32 s11, s11, 1
    s_cmp_gt_u32 s11, 131072
    s_cbranch_scc1 L_m_bo24
    s_waitcnt vmcnt(0)
    v_xor_b32 v40, s15, v40
    v_xor_b32 v41, s15, v41
    v_xor_b32 v42, s15, v42
    v_xor_b32 v43, s15, v43
    v_or3_b32 v40, v40, v41, v42
    v_or_b32 v40, v40, v43
    v_cmp_ne_u32 vcc, 0, v40
    s_nop 4
    s_cbranch_vccnz L_m_bl23
L_m_bo24:
    s_cmp_lg_u32 s2, 0
    s_cbranch_scc1 L_m_nb19
    s_mov_b32 s3, 274432
    s_mov_b64 s[10:11], exec
    s_mov_b64 exec, 1
    buffer_store_dword v241, v242, s[44:47], s3 offen sc1
    s_mov_b64 exec, s[10:11]
L_m_nb19:
    s_barrier
    s_mov_b32 s11, 0
L_m_ml25:
    s_mov_b32 s3, 0
    buffer_load_dwordx4 v[40:43], v5, s[20:23], s3 offen sc1
    s_mov_b32 s3, 2048
    buffer_load_dwordx4 v[44:47], v5, s[20:23], s3 offen sc1
    s_mov_b32 s3, 4096
    buffer_load_dwordx4 v[48:51], v5, s[20:23], s3 offen sc1
    s_mov_b32 s3, 6144
    buffer_load_dwordx4 v[52:55], v5, s[20:23], s3 offen sc1
    s_mov_b32 s3, 8192
    buffer_load_dwordx4 v[56:59], v5, s[20:23], s3 offen sc1
    s_add_u32 s11, s11, 1
    s_cmp_gt_u32 s11, 131072
    s_cbranch_scc1 L_m_mo26
    s_waitcnt vmcnt(0)
    v_max3_u32 v11, v40, v44, v48
    v_max3_u32 v11, v11, v52, v56
    v_cmp_eq_u32 vcc, -1, v11
    s_nop 4
    s_cbranch_vccnz L_m_ml25
L_m_mo26:
    v_lshlrev_b32 v104, 16, v44
    v_and_b32 v105, 0xffff0000, v44
    v_lshlrev_b32 v106, 16, v45
    v_and_b32 v107, 0xffff0000, v45
    v_lshlrev_b32 v108, 16, v46
    v_and_b32 v109, 0xffff0000, v46
    v_lshlrev_b32 v110, 16, v47
    v_and_b32 v111, 0xffff0000, v47
    v_lshlrev_b32 v96, 16, v40
    v_and_b32 v97, 0xffff0000, v40
    v_lshlrev_b32 v98, 16, v41
    v_and_b32 v99, 0xffff0000, v41
    v_lshlrev_b32 v100, 16, v42
    v_and_b32 v101, 0xffff0000, v42
    v_lshlrev_b32 v102, 16, v43
    v_and_b32 v103, 0xffff0000, v43
    v_pk_fma_f32 v[160:161], v[160:161], v[104:105], v[96:97]
    v_pk_fma_f32 v[162:163], v[162:163], v[106:107], v[98:99]
    v_pk_fma_f32 v[164:165], v[164:165], v[108:109], v[100:101]
    v_pk_fma_f32 v[166:167], v[166:167], v[110:111], v[102:103]
    v_pk_fma_f32 v[168:169], v[168:169], v[104:105], v[96:97]
    v_pk_fma_f32 v[170:171], v[170:171], v[106:107], v[98:99]
    v_pk_fma_f32 v[172:173], v[172:173], v[108:109], v[100:101]
    v_pk_fma_f32 v[174:175], v[174:175], v[110:111], v[102:103]
    v_pk_fma_f32 v[176:177], v[176:177], v[104:105], v[96:97]
    v_pk_fma_f32 v[178:179], v[178:179], v[106:107], v[98:99]
    v_pk_fma_f32 v[180:181], v[180:181], v[108:109], v[100:101]
    v_pk_fma_f32 v[182:183], v[182:183], v[110:111], v[102:103]
    v_pk_fma_f32 v[184:185], v[184:185], v[104:105], v[96:97]
    v_pk_fma_f32 v[186:187], v[186:187], v[106:107], v[98:99]
    v_pk_fma_f32 v[188:189], v[188:189], v[108:109], v[100:101]
    v_pk_fma_f32 v[190:191], v[190:191], v[110:111], v[102:103]
    v_lshlrev_b32 v112, 16, v48
    v_and_b32 v113, 0xffff0000, v48
    v_lshlrev_b32 v114, 16, v49
    v_and_b32 v115, 0xffff0000, v49
    v_lshlrev_b32 v116, 16, v50
    v_and_b32 v117, 0xffff0000, v50
    v_lshlrev_b32 v118, 16, v51
    v_and_b32 v119, 0xffff0000, v51
    v_pk_mul_f32 v[160:161], v[160:161], v[112:113]
    v_pk_mul_f32 v[162:163], v[162:163], v[114:115]
    v_pk_mul_f32 v[164:165], v[164:165], v[116:117]
    v_pk_mul_f32 v[166:167], v[166:167], v[118:119]
    v_pk_mul_f32 v[168:169], v[168:169], v[112:113]
    v_pk_mul_f32 v[170:171], v[170:171], v[114:115]
    v_pk_mul_f32 v[172:173], v[172:173], v[116:117]
    v_pk_mul_f32 v[174:175], v[174:175], v[118:119]
    v_pk_mul_f32 v[176:177], v[176:177], v[112:113]
    v_pk_mul_f32 v[178:179], v[178:179], v[114:115]
    v_pk_mul_f32 v[180:181], v[180:181], v[116:117]
    v_pk_mul_f32 v[182:183], v[182:183], v[118:119]
    v_pk_mul_f32 v[184:185], v[184:185], v[112:113]
    v_pk_mul_f32 v[186:187], v[186:187], v[114:115]
    v_pk_mul_f32 v[188:189], v[188:189], v[116:117]
    v_pk_mul_f32 v[190:191], v[190:191], v[118:119]
    s_barrier
    ds_read_b64 v[136:137], v16
    ds_read_b64 v[138:139], v17
    ds_read_b64 v[140:141], v18
    ds_read_b64 v[142:143], v19
    ds_read_b64 v[144:145], v20
    ds_read_b64 v[146:147], v21
    ds_read_b64 v[148:149], v22
    ds_read_b64 v[150:151], v23
    v_lshlrev_b32 v128, 16, v56
    v_and_b32 v129, 0xffff0000, v56
    v_lshlrev_b32 v130, 16, v57
    v_and_b32 v131, 0xffff0000, v57
    v_lshlrev_b32 v132, 16, v58
    v_and_b32 v133, 0xffff0000, v58
    v_lshlrev_b32 v134, 16, v59
    v_and_b32 v135, 0xffff0000, v59
    v_lshlrev_b32 v120, 16, v52
    v_and_b32 v121, 0xffff0000, v52
    v_lshlrev_b32 v122, 16, v53
    v_and_b32 v123, 0xffff0000, v53
    v_lshlrev_b32 v124, 16, v54
    v_and_b32 v125, 0xffff0000, v54
    v_lshlrev_b32 v126, 16, v55
    v_and_b32 v127, 0xffff0000, v55
    s_waitcnt lgkmcnt(7)
    v_lshlrev_b32 v208, 16, v136
    v_and_b32 v216, 0xffff0000, v136
    v_lshlrev_b32 v224, 16, v137
    v_and_b32 v232, 0xffff0000, v137
    s_waitcnt lgkmcnt(6)
    v_lshlrev_b32 v209, 16, v138
    v_and_b32 v217, 0xffff0000, v138
    v_lshlrev_b32 v225, 16, v139
    v_and_b32 v233, 0xffff0000, v139
    s_waitcnt lgkmcnt(5)
    v_lshlrev_b32 v210, 16, v140
    v_and_b32 v218, 0xffff0000, v140
    v_lshlrev_b32 v226, 16, v141
    v_and_b32 v234, 0xffff0000, v141
    s_waitcnt lgkmcnt(4)
    v_lshlrev_b32 v211, 16, v142
    v_and_b32 v219, 0xffff0000, v142
    v_lshlrev_b32 v227, 16, v143
    v_and_b32 v235, 0xffff0000, v143
    s_waitcnt lgkmcnt(3)
    v_lshlrev_b32 v212, 16, v144
    v_and_b32 v220, 0xffff0000, v144
    v_lshlrev_b32 v228, 16, v145
    v_and_b32 v236, 0xffff0000, v145
    s_waitcnt lgkmcnt(2)
    v_lshlrev_b32 v213, 16, v146
    v_and_b32 v221, 0xffff0000, v146
    v_lshlrev_b32 v229, 16, v147
    v_and_b32 v237, 0xffff0000, v147
    s_waitcnt lgkmcnt(1)
    v_lshlrev_b32 v214, 16, v148
    v_and_b32 v222, 0xffff0000, v148
    v_lshlrev_b32 v230, 16, v149
    v_and_b32 v238, 0xffff0000, v149
    s_waitcnt lgkmcnt(0)
    v_lshlrev_b32 v215, 16, v150
    v_and_b32 v223, 0xffff0000, v150
    v_lshlrev_b32 v231, 16, v151
    v_and_b32 v239, 0xffff0000, v151
    v_pk_fma_f32 v[64:65], v[160:161], v[208:209], v[64:65]
    v_pk_fma_f32 v[66:67], v[162:163], v[210:211], v[66:67]
    v_pk_fma_f32 v[68:69], v[164:165], v[212:213], v[68:69]
    v_pk_fma_f32 v[70:71], v[166:167], v[214:215], v[70:71]
    v_cvt_pk_bf16_f32 v24, v64, v65
    v_cvt_pk_bf16_f32 v25, v66, v67
    v_cvt_pk_bf16_f32 v26, v68, v69
    v_cvt_pk_bf16_f32 v27, v70, v71
    buffer_store_dwordx4 v[24:27], v4, s[24:27], 0 offen offset:0 sc1
    v_pk_fma_f32 v[72:73], v[168:169], v[216:217], v[72:73]
    v_pk_fma_f32 v[74:75], v[170:171], v[218:219], v[74:75]
    v_pk_fma_f32 v[76:77], v[172:173], v[220:221], v[76:77]
    v_pk_fma_f32 v[78:79], v[174:175], v[222:223], v[78:79]
    v_cvt_pk_bf16_f32 v28, v72, v73
    v_cvt_pk_bf16_f32 v29, v74, v75
    v_cvt_pk_bf16_f32 v30, v76, v77
    v_cvt_pk_bf16_f32 v31, v78, v79
    buffer_store_dwordx4 v[28:31], v4, s[24:27], 0 offen offset:2048 sc1
    v_pk_fma_f32 v[80:81], v[176:177], v[224:225], v[80:81]
    v_pk_fma_f32 v[82:83], v[178:179], v[226:227], v[82:83]
    v_pk_fma_f32 v[84:85], v[180:181], v[228:229], v[84:85]
    v_pk_fma_f32 v[86:87], v[182:183], v[230:231], v[86:87]
    v_cvt_pk_bf16_f32 v32, v80, v81
    v_cvt_pk_bf16_f32 v33, v82, v83
    v_cvt_pk_bf16_f32 v34, v84, v85
    v_cvt_pk_bf16_f32 v35, v86, v87
    buffer_store_dwordx4 v[32:35], v13, s[24:27], 0 offen offset:0 sc1
    v_pk_fma_f32 v[88:89], v[184:185], v[232:233], v[88:89]
    v_pk_fma_f32 v[90:91], v[186:187], v[234:235], v[90:91]
    v_pk_fma_f32 v[92:93], v[188:189], v[236:237], v[92:93]
    v_pk_fma_f32 v[94:95], v[190:191], v[238:239], v[94:95]
    v_cvt_pk_bf16_f32 v36, v88, v89
    v_cvt_pk_bf16_f32 v37, v90, v91
    v_cvt_pk_bf16_f32 v38, v92, v93
    v_cvt_pk_bf16_f32 v39, v94, v95
    buffer_store_dwordx4 v[36:39], v13, s[24:27], 0 offen offset:2048 sc1
    v_pk_add_f32 v[200:201], v[64:65], v[66:67]
    v_pk_mul_f32 v[202:203], v[64:65], v[64:65]
    v_pk_add_f32 v[204:205], v[68:69], v[70:71]
    v_pk_fma_f32 v[202:203], v[66:67], v[66:67], v[202:203]
    v_pk_fma_f32 v[202:203], v[68:69], v[68:69], v[202:203]
    v_pk_fma_f32 v[202:203], v[70:71], v[70:71], v[202:203]
    v_pk_add_f32 v[200:201], v[200:201], v[204:205]
    v_add_f32 v156, v202, v203
    v_add_f32 v152, v200, v201
    v_pk_add_f32 v[200:201], v[72:73], v[74:75]
    v_pk_mul_f32 v[202:203], v[72:73], v[72:73]
    v_pk_add_f32 v[204:205], v[76:77], v[78:79]
    v_pk_fma_f32 v[202:203], v[74:75], v[74:75], v[202:203]
    v_pk_fma_f32 v[202:203], v[76:77], v[76:77], v[202:203]
    v_pk_fma_f32 v[202:203], v[78:79], v[78:79], v[202:203]
    v_pk_add_f32 v[200:201], v[200:201], v[204:205]
    v_add_f32 v157, v202, v203
    v_add_f32 v153, v200, v201
    v_pk_add_f32 v[200:201], v[80:81], v[82:83]
    v_pk_mul_f32 v[202:203], v[80:81], v[80:81]
    v_pk_add_f32 v[204:205], v[84:85], v[86:87]
    v_pk_fma_f32 v[202:203], v[82:83], v[82:83], v[202:203]
    v_pk_fma_f32 v[202:203], v[84:85], v[84:85], v[202:203]
    v_pk_fma_f32 v[202:203], v[86:87], v[86:87], v[202:203]
    v_pk_add_f32 v[200:201], v[200:201], v[204:205]
    v_add_f32 v158, v202, v203
    v_add_f32 v154, v200, v201
    v_pk_add_f32 v[200:201], v[88:89], v[90:91]
    v_pk_mul_f32 v[202:203], v[88:89], v[88:89]
    v_pk_add_f32 v[204:205], v[92:93], v[94:95]
    v_pk_fma_f32 v[202:203], v[90:91], v[90:91], v[202:203]
    v_pk_fma_f32 v[202:203], v[92:93], v[92:93], v[202:203]
    v_pk_fma_f32 v[202:203], v[94:95], v[94:95], v[202:203]
    v_pk_add_f32 v[200:201], v[200:201], v[204:205]
    v_add_f32 v159, v202, v203
    v_add_f32 v155, v200, v201
    s_nop 1
    v_permlane32_swap_b32 v152, v154
    v_permlane32_swap_b32 v153, v155
    v_permlane32_swap_b32 v156, v158
    v_permlane32_swap_b32 v157, v159
    v_add_f32 v152, v152, v154
    v_add_f32 v153, v153, v155
    v_add_f32 v156, v156, v158
    v_add_f32 v157, v157, v159
    s_nop 0
    v_permlane16_swap_b32 v152, v153
    v_permlane16_swap_b32 v156, v157
    v_add_f32 v152, v152, v153
    v_add_f32 v156, v156, v157
    s_nop 0
    v_add_f32_dpp v152, v152, v152 quad_perm:[1,0,3,2] row_mask:0xf bank_mask:0xf
    v_add_f32_dpp v156, v156, v156 quad_perm:[1,0,3,2] row_mask:0xf bank_mask:0xf
    s_nop 0
    v_add_f32_dpp v152, v152, v152 quad_perm:[2,3,0,1] row_mask:0xf bank_mask:0xf
    v_add_f32_dpp v156, v156, v156 quad_perm:[2,3,0,1] row_mask:0xf bank_mask:0xf
    s_nop 0
    v_add_f32_dpp v152, v152, v152 row_ror:8 row_mask:0xf bank_mask:0xf
    v_add_f32_dpp v156, v156, v156 row_ror:8 row_mask:0xf bank_mask:0xf
    s_mov_b64 exec, s[52:53]
    ds_write_b32 v8, v152
    ds_write_b32 v8, v156 offset:16
    s_mov_b64 exec, -1
    s_waitcnt lgkmcnt(0)
    s_barrier
    ds_read_b128 v[160:163], v9 offset:16384
    ds_read_b128 v[164:167], v9 offset:16400
    ds_read_b128 v[168:171], v9 offset:16416
    ds_read_b128 v[172:175], v9 offset:16432
    ds_read_b128 v[176:179], v9 offset:16448
    ds_read_b128 v[180:183], v9 offset:16464
    ds_read_b128 v[184:187], v9 offset:16480
    ds_read_b128 v[188:191], v9 offset:16496
    s_waitcnt lgkmcnt(0)
    v_pk_add_f32 v[160:161], v[160:161], v[168:169]
    v_pk_add_f32 v[162:163], v[162:163], v[170:171]
    v_pk_add_f32 v[164:165], v[164:165], v[172:173]
    v_pk_add_f32 v[166:167], v[166:167], v[174:175]
    v_pk_add_f32 v[176:177], v[176:177], v[184:185]
    v_pk_add_f32 v[178:179], v[178:179], v[186:187]
    v_pk_add_f32 v[180:181], v[180:181], v[188:189]
    v_pk_add_f32 v[182:183], v[182:183], v[190:191]
    v_pk_add_f32 v[160:161], v[160:161], v[176:177]
    v_pk_add_f32 v[162:163], v[162:163], v[178:179]
    v_pk_add_f32 v[164:165], v[164:165], v[180:181]
    v_pk_add_f32 v[166:167], v[166:167], v[182:183]
    s_mov_b32 s10, 0x3a800000
    v_mul_f32 v160, s10, v160
    v_mul_f32 v161, s10, v161
    v_mul_f32 v162, s10, v162
    v_mul_f32 v163, s10, v163
    v_mul_f32 v168, v160, v160
    v_mul_f32 v169, v161, v161
    v_mul_f32 v170, v162, v162
    v_mul_f32 v171, v163, v163
    v_fma_f32 v164, v164, s10, -v168
    v_fma_f32 v165, v165, s10, -v169
    v_fma_f32 v166, v166, s10, -v170
    v_fma_f32 v167, v167, s10, -v171
    v_max_f32 v164, 0, v164
    v_max_f32 v165, 0, v165
    v_max_f32 v166, 0, v166
    v_max_f32 v167, 0, v167
    v_add_f32 v164, 0x3727c5ac, v164
    v_add_f32 v165, 0x3727c5ac, v165
    v_add_f32 v166, 0x3727c5ac, v166
    v_add_f32 v167, 0x3727c5ac, v167
    v_rsq_f32 v192, v164
    v_rsq_f32 v194, v165
    v_rsq_f32 v196, v166
    v_rsq_f32 v198, v167
    s_nop 0
    v_mul_f32_e64 v193, -v160, v192
    v_mul_f32_e64 v195, -v161, v194
    v_mul_f32_e64 v197, -v162, v196
    v_mul_f32_e64 v199, -v163, v198
    v_pk_fma_f32 v[200:201], v[64:65], v[192:193], v[192:193] op_sel:[0,0,1] op_sel_hi:[1,0,1]
    v_pk_fma_f32 v[202:203], v[66:67], v[192:193], v[192:193] op_sel:[0,0,1] op_sel_hi:[1,0,1]
    v_pk_fma_f32 v[204:205], v[68:69], v[192:193], v[192:193] op_sel:[0,0,1] op_sel_hi:[1,0,1]
    v_pk_fma_f32 v[206:207], v[70:71], v[192:193], v[192:193] op_sel:[0,0,1] op_sel_hi:[1,0,1]
    v_pk_fma_f32 v[200:201], v[200:201], v[128:129], v[120:121]
    v_pk_fma_f32 v[202:203], v[202:203], v[130:131], v[122:123]
    v_pk_fma_f32 v[204:205], v[204:205], v[132:133], v[124:125]
    v_pk_fma_f32 v[206:207], v[206:207], v[134:135], v[126:127]
    v_cvt_pk_bf16_f32 v136, v200, v201
    v_cvt_pk_bf16_f32 v137, v202, v203
    v_cvt_pk_bf16_f32 v138, v204, v205
    v_cvt_pk_bf16_f32 v139, v206, v207
    buffer_store_dwordx4 v[136:139], v4, s[28:31], 0 offen offset:0 sc1
    v_pk_fma_f32 v[200:201], v[72:73], v[194:195], v[194:195] op_sel:[0,0,1] op_sel_hi:[1,0,1]
    v_pk_fma_f32 v[202:203], v[74:75], v[194:195], v[194:195] op_sel:[0,0,1] op_sel_hi:[1,0,1]
    v_pk_fma_f32 v[204:205], v[76:77], v[194:195], v[194:195] op_sel:[0,0,1] op_sel_hi:[1,0,1]
    v_pk_fma_f32 v[206:207], v[78:79], v[194:195], v[194:195] op_sel:[0,0,1] op_sel_hi:[1,0,1]
    v_pk_fma_f32 v[200:201], v[200:201], v[128:129], v[120:121]
    v_pk_fma_f32 v[202:203], v[202:203], v[130:131], v[122:123]
    v_pk_fma_f32 v[204:205], v[204:205], v[132:133], v[124:125]
    v_pk_fma_f32 v[206:207], v[206:207], v[134:135], v[126:127]
    v_cvt_pk_bf16_f32 v140, v200, v201
    v_cvt_pk_bf16_f32 v141, v202, v203
    v_cvt_pk_bf16_f32 v142, v204, v205
    v_cvt_pk_bf16_f32 v143, v206, v207
    buffer_store_dwordx4 v[140:143], v4, s[28:31], 0 offen offset:2048 sc1
    v_pk_fma_f32 v[200:201], v[80:81], v[196:197], v[196:197] op_sel:[0,0,1] op_sel_hi:[1,0,1]
    v_pk_fma_f32 v[202:203], v[82:83], v[196:197], v[196:197] op_sel:[0,0,1] op_sel_hi:[1,0,1]
    v_pk_fma_f32 v[204:205], v[84:85], v[196:197], v[196:197] op_sel:[0,0,1] op_sel_hi:[1,0,1]
    v_pk_fma_f32 v[206:207], v[86:87], v[196:197], v[196:197] op_sel:[0,0,1] op_sel_hi:[1,0,1]
    v_pk_fma_f32 v[200:201], v[200:201], v[128:129], v[120:121]
    v_pk_fma_f32 v[202:203], v[202:203], v[130:131], v[122:123]
    v_pk_fma_f32 v[204:205], v[204:205], v[132:133], v[124:125]
    v_pk_fma_f32 v[206:207], v[206:207], v[134:135], v[126:127]
    v_cvt_pk_bf16_f32 v144, v200, v201
    v_cvt_pk_bf16_f32 v145, v202, v203
    v_cvt_pk_bf16_f32 v146, v204, v205
    v_cvt_pk_bf16_f32 v147, v206, v207
    buffer_store_dwordx4 v[144:147], v13, s[28:31], 0 offen offset:0 sc1
    v_pk_fma_f32 v[200:201], v[88:89], v[198:199], v[198:199] op_sel:[0,0,1] op_sel_hi:[1,0,1]
    v_pk_fma_f32 v[202:203], v[90:91], v[198:199], v[198:199] op_sel:[0,0,1] op_sel_hi:[1,0,1]
    v_pk_fma_f32 v[204:205], v[92:93], v[198:199], v[198:199] op_sel:[0,0,1] op_sel_hi:[1,0,1]
    v_pk_fma_f32 v[206:207], v[94:95], v[198:199], v[198:199] op_sel:[0,0,1] op_sel_hi:[1,0,1]
    v_pk_fma_f32 v[200:201], v[200:201], v[128:129], v[120:121]
    v_pk_fma_f32 v[202:203], v[202:203], v[130:131], v[122:123]
    v_pk_fma_f32 v[204:205], v[204:205], v[132:133], v[124:125]
    v_pk_fma_f32 v[206:207], v[206:207], v[134:135], v[126:127]
    v_cvt_pk_bf16_f32 v148, v200, v201
    v_cvt_pk_bf16_f32 v149, v202, v203
    v_cvt_pk_bf16_f32 v150, v204, v205
    v_cvt_pk_bf16_f32 v151, v206, v207
    buffer_store_dwordx4 v[148:151], v13, s[28:31], 0 offen offset:2048 sc1
    s_waitcnt vmcnt(0)
    s_barrier
    s_cmp_lg_u32 s18, 0
    s_cbranch_scc1 L_m_nf27
    s_lshr_b32 s3, s97, 4
    s_lshl_b32 s3, s3, 12
    s_and_b32 s19, s97, 15
    s_lshl_b32 s19, s19, 7
    s_add_u32 s3, s3, s19
    s_add_u32 s3, s3, 360448
    v_lshlrev_b32 v10, 11, v1
    s_mov_b64 exec, 3
    buffer_store_dword v241, v10, s[44:47], s3 offen sc1
    s_mov_b64 exec, -1
L_m_nf27:
    s_cmp_ge_u32 s17, 28
    s_cbranch_scc1 L_m_cspare
    s_mov_b32 s32, s94
    s_mov_b32 s33, s95
    s_mov_b32 s34, 7340032
    s_mov_b32 s35, 0x20000
    s_add_u32 s40, s94, 16777216
    s_addc_u32 s41, s95, 0
    s_mov_b32 s42, 7340032
    s_mov_b32 s43, 0x20000
    s_mov_b32 s36, s82
    s_mov_b32 s37, s83
    s_mov_b32 s38, 4096
    s_mov_b32 s39, 0x20000
    s_and_b32 s48, s18, 1
    s_lshr_b32 s49, s18, 1
    v_and_b32 v20, 15, v1
    v_lshrrev_b32 v21, 4, v1
    v_bfe_u32 v22, v1, 2, 2
    v_and_b32 v23, 3, v1
    s_lshl_b32 s3, s12, 7
    s_lshl_b32 s19, s48, 6
    s_add_u32 s3, s3, s19
    s_lshl_b32 s3, s3, 1
    v_lshl_add_u32 v30, v20, 1, s3
    v_lshrrev_b32 v24, 1, v20
    v_xor_b32 v24, v24, v21
    v_lshlrev_b32 v24, 4, v24
    v_lshl_add_u32 v24, v20, 7, v24
    s_lshl_b32 s3, s48, 13
    v_add_u32 v2, s3, v24
    v_xor_b32 v3, 64, v2
    v_lshl_add_u32 v24, v21, 3, v22
    v_lshlrev_b32 v24, 8, v24
    v_lshl_add_u32 v24, v23, 3, v24
    v_and_b32 v25, 1, v21
    v_xor_b32 v25, s49, v25
    v_lshl_add_u32 v24, v25, 7, v24
    v_add_u32 v24, 65536, v24
    v_xor_b32 v25, 0, v22
    v_lshl_add_u32 v4, v25, 5, v24
    v_add_u32 v5, 1024, v4
    v_xor_b32 v25, 1, v22
    v_lshl_add_u32 v6, v25, 5, v24
    v_add_u32 v7, 1024, v6
    v_xor_b32 v25, 2, v22
    v_lshl_add_u32 v8, v25, 5, v24
    v_add_u32 v9, 1024, v8
    v_xor_b32 v25, 3, v22
    v_lshl_add_u32 v10, v25, 5, v24
    v_add_u32 v11, 1024, v10
    v_and_b32 v24, 1, v21
    v_lshl_add_u32 v24, v24, 3, v22
    v_lshrrev_b32 v25, 1, v23
    v_lshl_add_u32 v24, v25, 2, v24
    v_lshl_add_u32 v24, v25, 5, v24
    v_lshrrev_b32 v25, 1, v21
    v_lshl_add_u32 v24, v25, 4, v24
    v_lshlrev_b32 v24, 4, v24
    v_and_b32 v25, 1, v23
    v_lshl_add_u32 v24, v25, 3, v24
    s_lshl_b32 s3, s49, 12
    s_add_u32 s3, s3, 65536
    v_add_u32 v12, s3, v24
    v_xor_b32 v13, 64, v12
    s_lshl_b32 s3, s49, 10
    s_lshl_b32 s19, s48, 9
    s_add_u32 s3, s3, s19
    s_add_u32 s3, s3, 131072
    v_lshl_add_u32 v14, v1, 3, s3
    s_add_u32 s3, s19, 133120
    v_lshl_add_u32 v15, v20, 3, s3
    v_lshrrev_b32 v24, 1, v21
    v_lshlrev_b32 v24, 2, v24
    v_xor_b32 v24, v24, v20
    v_lshl_add_u32 v24, v21, 4, v24
    s_lshl_b32 s3, s13, 19
    s_lshl_b32 s19, s12, 15
    s_add_u32 s3, s3, s19
    s_lshl_b32 s19, s48, 14
    s_add_u32 s3, s3, s19
    s_lshl_b32 s19, s49, 12
    s_add_u32 s3, s3, s19
    v_lshl_add_u32 v28, v24, 4, s3
    s_mul_i32 s3, s12, 458752
    s_lshl_b32 s19, s13, 15
    s_add_u32 s3, s3, s19
    s_lshl_b32 s19, s49, 14
    s_add_u32 s3, s3, s19
    s_lshl_b32 s19, s48, 12
    s_add_u32 s3, s3, s19
    v_lshl_add_u32 v29, v1, 4, s3
    s_mov_b32 s52, 0xbdd2d3e8
    s_mov_b32 s53, 0xbdd2d3e8
    s_mov_b32 s54, 8192
    v_mov_b32 v16, 0xc0135761
    v_mov_b32 v17, 0xc0135761
    v_mov_b32 v18, 1.0
    v_mov_b32 v19, 1.0
    s_mov_b32 s50, 0
    s_mov_b32 s51, 65808
    s_mov_b32 s55, 96
    s_mov_b64 vcc, 0
    s_waitcnt vmcnt(0)
    s_barrier
    ds_read_b128 v[160:163], v2 offset:0
    ds_read_b64_tr_b16 v[176:177], v4 offset:0
    ds_read_b64_tr_b16 v[178:179], v5 offset:0
    ds_read_b128 v[164:167], v2 offset:2048
    ds_read_b128 v[168:171], v2 offset:4096
    ds_read_b128 v[172:175], v2 offset:6144
    ds_read_b64_tr_b16 v[180:181], v6 offset:0
    ds_read_b64_tr_b16 v[182:183], v7 offset:0
    ds_read_b64_tr_b16 v[184:185], v8 offset:0
    ds_read_b64_tr_b16 v[186:187], v9 offset:0
    ds_read_b64_tr_b16 v[188:189], v10 offset:0
    ds_read_b64_tr_b16 v[190:191], v11 offset:0
L_m_kfirst:
    s_waitcnt lgkmcnt(9)
    v_mfma_f32_16x16x32_bf16 v[32:35], v[176:179], v[160:163], 0
    ds_read_b128 v[192:195], v3 offset:0
    s_waitcnt lgkmcnt(9)
    v_mfma_f32_16x16x32_bf16 v[48:51], v[176:179], v[164:167], 0
    ds_read_b64_tr_b16 v[208:209], v4 offset:8192
    s_waitcnt lgkmcnt(9)
    v_mfma_f32_16x16x32_bf16 v[64:67], v[176:179], v[168:171], 0
    ds_read_b64_tr_b16 v[210:211], v5 offset:8192
    s_waitcnt lgkmcnt(9)
    v_mfma_f32_16x16x32_bf16 v[80:83], v[176:179], v[172:175], 0
    ds_read_b128 v[196:199], v3 offset:2048
    s_waitcnt lgkmcnt(8)
    v_mfma_f32_16x16x32_bf16 v[84:87], v[180:183], v[172:175], 0
    ds_read_b128 v[200:203], v3 offset:4096
    v_mfma_f32_16x16x32_bf16 v[68:71], v[180:183], v[168:171], 0
    ds_read_b128 v[204:207], v3 offset:6144
    v_mfma_f32_16x16x32_bf16 v[52:55], v[180:183], v[164:167], 0
    ds_read_b64_tr_b16 v[212:213], v6 offset:8192
    v_mfma_f32_16x16x32_bf16 v[36:39], v[180:183], v[160:163], 0
    ds_read_b64_tr_b16 v[214:215], v7 offset:8192
    s_waitcnt lgkmcnt(10)
    v_mfma_f32_16x16x32_bf16 v[40:43], v[184:187], v[160:163], 0
    ds_read_b64_tr_b16 v[216:217], v8 offset:8192
    v_mfma_f32_16x16x32_bf16 v[56:59], v[184:187], v[164:167], 0
    ds_read_b64_tr_b16 v[218:219], v9 offset:8192
    v_mfma_f32_16x16x32_bf16 v[72:75], v[184:187], v[168:171], 0
    ds_read_b64_tr_b16 v[220:221], v10 offset:8192
    v_mfma_f32_16x16x32_bf16 v[88:91], v[184:187], v[172:175], 0
    ds_read_b64_tr_b16 v[222:223], v11 offset:8192
    s_waitcnt lgkmcnt(12)
    v_mfma_f32_16x16x32_bf16 v[92:95], v[188:191], v[172:175], 0
    v_mfma_f32_16x16x32_bf16 v[76:79], v[188:191], v[168:171], 0
    v_mfma_f32_16x16x32_bf16 v[60:63], v[188:191], v[164:167], 0
    v_mfma_f32_16x16x32_bf16 v[44:47], v[188:191], v[160:163], 0
    s_branch L_m_kmid
L_m_ktop:
    s_waitcnt lgkmcnt(9)
    v_mfma_f32_16x16x32_bf16 v[32:35], v[176:179], v[160:163], v[32:35]
    ds_read_b128 v[192:195], v3 offset:0
    s_waitcnt lgkmcnt(9)
    v_mfma_f32_16x16x32_bf16 v[48:51], v[176:179], v[164:167], v[48:51]
    ds_read_b64_tr_b16 v[208:209], v4 offset:8192
    s_waitcnt lgkmcnt(9)
    v_mfma_f32_16x16x32_bf16 v[64:67], v[176:179], v[168:171], v[64:67]
    ds_read_b64_tr_b16 v[210:211], v5 offset:8192
    s_waitcnt lgkmcnt(9)
    v_mfma_f32_16x16x32_bf16 v[80:83], v[176:179], v[172:175], v[80:83]
    ds_read_b128 v[196:199], v3 offset:2048
    s_waitcnt lgkmcnt(8)
    v_mfma_f32_16x16x32_bf16 v[84:87], v[180:183], v[172:175], v[84:87]
    ds_read_b128 v[200:203], v3 offset:4096
    v_mfma_f32_16x16x32_bf16 v[68:71], v[180:183], v[168:171], v[68:71]
    ds_read_b128 v[204:207], v3 offset:6144
    v_mfma_f32_16x16x32_bf16 v[52:55], v[180:183], v[164:167], v[52:55]
    ds_read_b64_tr_b16 v[212:213], v6 offset:8192
    v_mfma_f32_16x16x32_bf16 v[36:39], v[180:183], v[160:163], v[36:39]
    ds_read_b64_tr_b16 v[214:215], v7 offset:8192
    s_waitcnt lgkmcnt(10)
    v_mfma_f32_16x16x32_bf16 v[40:43], v[184:187], v[160:163], v[40:43]
    ds_read_b64_tr_b16 v[216:217], v8 offset:8192
    v_mfma_f32_16x16x32_bf16 v[56:59], v[184:187], v[164:167], v[56:59]
    ds_read_b64_tr_b16 v[218:219], v9 offset:8192
    v_mfma_f32_16x16x32_bf16 v[72:75], v[184:187], v[168:171], v[72:75]
    ds_read_b64_tr_b16 v[220:221], v10 offset:8192
    v_mfma_f32_16x16x32_bf16 v[88:91], v[184:187], v[172:175], v[88:91]
    ds_read_b64_tr_b16 v[222:223], v11 offset:8192
    s_waitcnt lgkmcnt(12)
    v_mfma_f32_16x16x32_bf16 v[92:95], v[188:191], v[172:175], v[92:95]
    v_mfma_f32_16x16x32_bf16 v[76:79], v[188:191], v[168:171], v[76:79]
    v_mfma_f32_16x16x32_bf16 v[60:63], v[188:191], v[164:167], v[60:63]
    v_mfma_f32_16x16x32_bf16 v[44:47], v[188:191], v[160:163], v[44:47]
L_m_kmid:
    s_waitcnt vmcnt(0) lgkmcnt(0)
    s_barrier
    v_mfma_f32_16x16x32_bf16 v[32:35], v[208:211], v[192:195], v[32:35]
    ds_read_b128 v[160:163], v2 offset:16384
    v_mfma_f32_16x16x32_bf16 v[48:51], v[208:211], v[196:199], v[48:51]
    ds_read_b64_tr_b16 v[176:177], v4 offset:16384
    v_mfma_f32_16x16x32_bf16 v[64:67], v[208:211], v[200:203], v[64:67]
    ds_read_b64_tr_b16 v[178:179], v5 offset:16384
    v_mfma_f32_16x16x32_bf16 v[80:83], v[208:211], v[204:207], v[80:83]
    ds_read_b128 v[164:167], v2 offset:18432
    v_mfma_f32_16x16x32_bf16 v[84:87], v[212:215], v[204:207], v[84:87]
    ds_read_b128 v[168:171], v2 offset:20480
    v_mfma_f32_16x16x32_bf16 v[68:71], v[212:215], v[200:203], v[68:71]
    ds_read_b128 v[172:175], v2 offset:22528
    v_mfma_f32_16x16x32_bf16 v[52:55], v[212:215], v[196:199], v[52:55]
    ds_read_b64_tr_b16 v[180:181], v6 offset:16384
    v_mfma_f32_16x16x32_bf16 v[36:39], v[212:215], v[192:195], v[36:39]
    ds_read_b64_tr_b16 v[182:183], v7 offset:16384
    v_mfma_f32_16x16x32_bf16 v[40:43], v[216:219], v[192:195], v[40:43]
    ds_read_b64_tr_b16 v[184:185], v8 offset:16384
    v_mfma_f32_16x16x32_bf16 v[56:59], v[216:219], v[196:199], v[56:59]
    ds_read_b64_tr_b16 v[186:187], v9 offset:16384
    v_mfma_f32_16x16x32_bf16 v[72:75], v[216:219], v[200:203], v[72:75]
    ds_read_b64_tr_b16 v[188:189], v10 offset:16384
    v_mfma_f32_16x16x32_bf16 v[88:91], v[216:219], v[204:207], v[88:91]
    ds_read_b64_tr_b16 v[190:191], v11 offset:16384
    v_mfma_f32_16x16x32_bf16 v[92:95], v[220:223], v[204:207], v[92:95]
    v_mfma_f32_16x16x32_bf16 v[76:79], v[220:223], v[200:203], v[76:79]
    v_mfma_f32_16x16x32_bf16 v[60:63], v[220:223], v[196:199], v[60:63]
    v_mfma_f32_16x16x32_bf16 v[44:47], v[220:223], v[192:195], v[44:47]
    s_waitcnt lgkmcnt(9)
    v_mfma_f32_16x16x32_bf16 v[32:35], v[176:179], v[160:163], v[32:35]
    ds_read_b128 v[192:195], v3 offset:16384
    s_waitcnt lgkmcnt(9)
    v_mfma_f32_16x16x32_bf16 v[48:51], v[176:179], v[164:167], v[48:51]
    ds_read_b64_tr_b16 v[208:209], v4 offset:24576
    s_waitcnt lgkmcnt(9)
    v_mfma_f32_16x16x32_bf16 v[64:67], v[176:179], v[168:171], v[64:67]
    ds_read_b64_tr_b16 v[210:211], v5 offset:24576
    s_waitcnt lgkmcnt(9)
    v_mfma_f32_16x16x32_bf16 v[80:83], v[176:179], v[172:175], v[80:83]
    ds_read_b128 v[196:199], v3 offset:18432
    s_waitcnt lgkmcnt(8)
    v_mfma_f32_16x16x32_bf16 v[84:87], v[180:183], v[172:175], v[84:87]
    ds_read_b128 v[200:203], v3 offset:20480
    v_mfma_f32_16x16x32_bf16 v[68:71], v[180:183], v[168:171], v[68:71]
    ds_read_b128 v[204:207], v3 offset:22528
    v_mfma_f32_16x16x32_bf16 v[52:55], v[180:183], v[164:167], v[52:55]
    ds_read_b64_tr_b16 v[212:213], v6 offset:24576
    v_mfma_f32_16x16x32_bf16 v[36:39], v[180:183], v[160:163], v[36:39]
    ds_read_b64_tr_b16 v[214:215], v7 offset:24576
    s_waitcnt lgkmcnt(10)
    v_mfma_f32_16x16x32_bf16 v[40:43], v[184:187], v[160:163], v[40:43]
    ds_read_b64_tr_b16 v[216:217], v8 offset:24576
    v_mfma_f32_16x16x32_bf16 v[56:59], v[184:187], v[164:167], v[56:59]
    ds_read_b64_tr_b16 v[218:219], v9 offset:24576
    v_mfma_f32_16x16x32_bf16 v[72:75], v[184:187], v[168:171], v[72:75]
    ds_read_b64_tr_b16 v[220:221], v10 offset:24576
    v_mfma_f32_16x16x32_bf16 v[88:91], v[184:187], v[172:175], v[88:91]
    ds_read_b64_tr_b16 v[222:223], v11 offset:24576
    s_waitcnt lgkmcnt(12)
    v_mfma_f32_16x16x32_bf16 v[92:95], v[188:191], v[172:175], v[92:95]
    v_mfma_f32_16x16x32_bf16 v[76:79], v[188:191], v[168:171], v[76:79]
    v_mfma_f32_16x16x32_bf16 v[60:63], v[188:191], v[164:167], v[60:63]
    v_mfma_f32_16x16x32_bf16 v[44:47], v[188:191], v[160:163], v[44:47]
    s_waitcnt lgkmcnt(0)
    s_barrier
    v_mfma_f32_16x16x32_bf16 v[32:35], v[208:211], v[192:195], v[32:35]
    ds_read_b128 v[160:163], v2 offset:32768
    v_mfma_f32_16x16x32_bf16 v[48:51], v[208:211], v[196:199], v[48:51]
    ds_read_b64_tr_b16 v[176:177], v4 offset:32768
    v_mfma_f32_16x16x32_bf16 v[64:67], v[208:211], v[200:203], v[64:67]
    ds_read_b64_tr_b16 v[178:179], v5 offset:32768
    v_mfma_f32_16x16x32_bf16 v[80:83], v[208:211], v[204:207], v[80:83]
    ds_read_b128 v[164:167], v2 offset:34816
    v_mfma_f32_16x16x32_bf16 v[84:87], v[212:215], v[204:207], v[84:87]
    ds_read_b128 v[168:171], v2 offset:36864
    v_mfma_f32_16x16x32_bf16 v[68:71], v[212:215], v[200:203], v[68:71]
    ds_read_b128 v[172:175], v2 offset:38912
    v_mfma_f32_16x16x32_bf16 v[52:55], v[212:215], v[196:199], v[52:55]
    ds_read_b64_tr_b16 v[180:181], v6 offset:32768
    v_mfma_f32_16x16x32_bf16 v[36:39], v[212:215], v[192:195], v[36:39]
    ds_read_b64_tr_b16 v[182:183], v7 offset:32768
    v_mfma_f32_16x16x32_bf16 v[40:43], v[216:219], v[192:195], v[40:43]
    ds_read_b64_tr_b16 v[184:185], v8 offset:32768
    v_mfma_f32_16x16x32_bf16 v[56:59], v[216:219], v[196:199], v[56:59]
    ds_read_b64_tr_b16 v[186:187], v9 offset:32768
    v_mfma_f32_16x16x32_bf16 v[72:75], v[216:219], v[200:203], v[72:75]
    ds_read_b64_tr_b16 v[188:189], v10 offset:32768
    v_mfma_f32_16x16x32_bf16 v[88:91], v[216:219], v[204:207], v[88:91]
    ds_read_b64_tr_b16 v[190:191], v11 offset:32768
    v_mfma_f32_16x16x32_bf16 v[92:95], v[220:223], v[204:207], v[92:95]
    v_mfma_f32_16x16x32_bf16 v[76:79], v[220:223], v[200:203], v[76:79]
    v_mfma_f32_16x16x32_bf16 v[60:63], v[220:223], v[196:199], v[60:63]
    v_mfma_f32_16x16x32_bf16 v[44:47], v[220:223], v[192:195], v[44:47]
    s_waitcnt lgkmcnt(9)
    v_mfma_f32_16x16x32_bf16 v[32:35], v[176:179], v[160:163], v[32:35]
    ds_read_b128 v[192:195], v3 offset:32768
    s_waitcnt lgkmcnt(9)
    v_mfma_f32_16x16x32_bf16 v[48:51], v[176:179], v[164:167], v[48:51]
    ds_read_b64_tr_b16 v[208:209], v4 offset:40960
    s_waitcnt lgkmcnt(9)
    v_mfma_f32_16x16x32_bf16 v[64:67], v[176:179], v[168:171], v[64:67]
    ds_read_b64_tr_b16 v[210:211], v5 offset:40960
    s_waitcnt lgkmcnt(9)
    v_mfma_f32_16x16x32_bf16 v[80:83], v[176:179], v[172:175], v[80:83]
    ds_read_b128 v[196:199], v3 offset:34816
    s_waitcnt lgkmcnt(8)
    v_mfma_f32_16x16x32_bf16 v[84:87], v[180:183], v[172:175], v[84:87]
    ds_read_b128 v[200:203], v3 offset:36864
    v_mfma_f32_16x16x32_bf16 v[68:71], v[180:183], v[168:171], v[68:71]
    ds_read_b128 v[204:207], v3 offset:38912
    v_mfma_f32_16x16x32_bf16 v[52:55], v[180:183], v[164:167], v[52:55]
    ds_read_b64_tr_b16 v[212:213], v6 offset:40960
    v_mfma_f32_16x16x32_bf16 v[36:39], v[180:183], v[160:163], v[36:39]
    ds_read_b64_tr_b16 v[214:215], v7 offset:40960
    s_waitcnt lgkmcnt(10)
    v_mfma_f32_16x16x32_bf16 v[40:43], v[184:187], v[160:163], v[40:43]
    ds_read_b64_tr_b16 v[216:217], v8 offset:40960
    v_mfma_f32_16x16x32_bf16 v[56:59], v[184:187], v[164:167], v[56:59]
    ds_read_b64_tr_b16 v[218:219], v9 offset:40960
    v_mfma_f32_16x16x32_bf16 v[72:75], v[184:187], v[168:171], v[72:75]
    ds_read_b64_tr_b16 v[220:221], v10 offset:40960
    v_mfma_f32_16x16x32_bf16 v[88:91], v[184:187], v[172:175], v[88:91]
    ds_read_b64_tr_b16 v[222:223], v11 offset:40960
    s_waitcnt lgkmcnt(12)
    v_mfma_f32_16x16x32_bf16 v[92:95], v[188:191], v[172:175], v[92:95]
    v_mfma_f32_16x16x32_bf16 v[76:79], v[188:191], v[168:171], v[76:79]
    v_mfma_f32_16x16x32_bf16 v[60:63], v[188:191], v[164:167], v[60:63]
    v_mfma_f32_16x16x32_bf16 v[44:47], v[188:191], v[160:163], v[44:47]
    s_waitcnt lgkmcnt(0)
    s_barrier
    v_mfma_f32_16x16x32_bf16 v[32:35], v[208:211], v[192:195], v[32:35]
    ds_read_b128 v[160:163], v2 offset:49152
    v_mfma_f32_16x16x32_bf16 v[48:51], v[208:211], v[196:199], v[48:51]
    ds_read_b64_tr_b16 v[176:177], v4 offset:49152
    v_mfma_f32_16x16x32_bf16 v[64:67], v[208:211], v[200:203], v[64:67]
    ds_read_b64_tr_b16 v[178:179], v5 offset:49152
    v_mfma_f32_16x16x32_bf16 v[80:83], v[208:211], v[204:207], v[80:83]
    ds_read_b128 v[164:167], v2 offset:51200
    v_mfma_f32_16x16x32_bf16 v[84:87], v[212:215], v[204:207], v[84:87]
    ds_read_b128 v[168:171], v2 offset:53248
    v_mfma_f32_16x16x32_bf16 v[68:71], v[212:215], v[200:203], v[68:71]
    ds_read_b128 v[172:175], v2 offset:55296
    v_mfma_f32_16x16x32_bf16 v[52:55], v[212:215], v[196:199], v[52:55]
    ds_read_b64_tr_b16 v[180:181], v6 offset:49152
    v_mfma_f32_16x16x32_bf16 v[36:39], v[212:215], v[192:195], v[36:39]
    ds_read_b64_tr_b16 v[182:183], v7 offset:49152
    v_mfma_f32_16x16x32_bf16 v[40:43], v[216:219], v[192:195], v[40:43]
    ds_read_b64_tr_b16 v[184:185], v8 offset:49152
    v_mfma_f32_16x16x32_bf16 v[56:59], v[216:219], v[196:199], v[56:59]
    ds_read_b64_tr_b16 v[186:187], v9 offset:49152
    v_mfma_f32_16x16x32_bf16 v[72:75], v[216:219], v[200:203], v[72:75]
    ds_read_b64_tr_b16 v[188:189], v10 offset:49152
    v_mfma_f32_16x16x32_bf16 v[88:91], v[216:219], v[204:207], v[88:91]
    ds_read_b64_tr_b16 v[190:191], v11 offset:49152
    v_mfma_f32_16x16x32_bf16 v[92:95], v[220:223], v[204:207], v[92:95]
    s_bitcmp1_b32 s55, s50
    v_mfma_f32_16x16x32_bf16 v[76:79], v[220:223], v[200:203], v[76:79]
    v_mfma_f32_16x16x32_bf16 v[60:63], v[220:223], v[196:199], v[60:63]
    v_mfma_f32_16x16x32_bf16 v[44:47], v[220:223], v[192:195], v[44:47]
    s_cbranch_scc1 L_m_knorm
L_m_knormr:
    s_waitcnt lgkmcnt(9)
    v_mfma_f32_16x16x32_bf16 v[32:35], v[176:179], v[160:163], v[32:35]
    ds_read_b128 v[192:195], v3 offset:49152
    s_waitcnt lgkmcnt(9)
    v_mfma_f32_16x16x32_bf16 v[48:51], v[176:179], v[164:167], v[48:51]
    ds_read_b64_tr_b16 v[208:209], v4 offset:57344
    s_waitcnt lgkmcnt(9)
    v_mfma_f32_16x16x32_bf16 v[64:67], v[176:179], v[168:171], v[64:67]
    ds_read_b64_tr_b16 v[210:211], v5 offset:57344
    s_waitcnt lgkmcnt(9)
    v_mfma_f32_16x16x32_bf16 v[80:83], v[176:179], v[172:175], v[80:83]
    ds_read_b128 v[196:199], v3 offset:51200
    s_waitcnt lgkmcnt(8)
    v_mfma_f32_16x16x32_bf16 v[84:87], v[180:183], v[172:175], v[84:87]
    ds_read_b128 v[200:203], v3 offset:53248
    v_mfma_f32_16x16x32_bf16 v[68:71], v[180:183], v[168:171], v[68:71]
    ds_read_b128 v[204:207], v3 offset:55296
    v_mfma_f32_16x16x32_bf16 v[52:55], v[180:183], v[164:167], v[52:55]
    ds_read_b64_tr_b16 v[212:213], v6 offset:57344
    v_mfma_f32_16x16x32_bf16 v[36:39], v[180:183], v[160:163], v[36:39]
    ds_read_b64_tr_b16 v[214:215], v7 offset:57344
    s_waitcnt lgkmcnt(10)
    v_mfma_f32_16x16x32_bf16 v[40:43], v[184:187], v[160:163], v[40:43]
    ds_read_b64_tr_b16 v[216:217], v8 offset:57344
    v_mfma_f32_16x16x32_bf16 v[56:59], v[184:187], v[164:167], v[56:59]
    ds_read_b64_tr_b16 v[218:219], v9 offset:57344
    v_mfma_f32_16x16x32_bf16 v[72:75], v[184:187], v[168:171], v[72:75]
    ds_read_b64_tr_b16 v[220:221], v10 offset:57344
    v_mfma_f32_16x16x32_bf16 v[88:91], v[184:187], v[172:175], v[88:91]
    ds_read_b64_tr_b16 v[222:223], v11 offset:57344
    s_waitcnt lgkmcnt(12)
    v_mfma_f32_16x16x32_bf16 v[92:95], v[188:191], v[172:175], v[92:95]
    s_cmp_eq_u32 s50, 7
    v_mfma_f32_16x16x32_bf16 v[76:79], v[188:191], v[168:171], v[76:79]
    v_mfma_f32_16x16x32_bf16 v[60:63], v[188:191], v[164:167], v[60:63]
    v_mfma_f32_16x16x32_bf16 v[44:47], v[188:191], v[160:163], v[44:47]
    s_waitcnt lgkmcnt(0)
    s_barrier
    s_cbranch_scc1 L_m_ksw
L_m_kswr:
    v_mfma_f32_16x16x32_bf16 v[32:35], v[208:211], v[192:195], v[32:35]
    ds_read_b128 v[160:163], v2 offset:0
    v_mfma_f32_16x16x32_bf16 v[48:51], v[208:211], v[196:199], v[48:51]
    ds_read_b64_tr_b16 v[176:177], v4 offset:0
    v_mfma_f32_16x16x32_bf16 v[64:67], v[208:211], v[200:203], v[64:67]
    ds_read_b64_tr_b16 v[178:179], v5 offset:0
    v_mfma_f32_16x16x32_bf16 v[80:83], v[208:211], v[204:207], v[80:83]
    ds_read_b128 v[164:167], v2 offset:2048
    v_mfma_f32_16x16x32_bf16 v[84:87], v[212:215], v[204:207], v[84:87]
    ds_read_b128 v[168:171], v2 offset:4096
    v_mfma_f32_16x16x32_bf16 v[68:71], v[212:215], v[200:203], v[68:71]
    ds_read_b128 v[172:175], v2 offset:6144
    v_mfma_f32_16x16x32_bf16 v[52:55], v[212:215], v[196:199], v[52:55]
    ds_read_b64_tr_b16 v[180:181], v6 offset:0
    v_mfma_f32_16x16x32_bf16 v[36:39], v[212:215], v[192:195], v[36:39]
    ds_read_b64_tr_b16 v[182:183], v7 offset:0
    v_mfma_f32_16x16x32_bf16 v[40:43], v[216:219], v[192:195], v[40:43]
    ds_read_b64_tr_b16 v[184:185], v8 offset:0
    v_mfma_f32_16x16x32_bf16 v[56:59], v[216:219], v[196:199], v[56:59]
    ds_read_b64_tr_b16 v[186:187], v9 offset:0
    v_mfma_f32_16x16x32_bf16 v[72:75], v[216:219], v[200:203], v[72:75]
    ds_read_b64_tr_b16 v[188:189], v10 offset:0
    v_mfma_f32_16x16x32_bf16 v[88:91], v[216:219], v[204:207], v[88:91]
    ds_read_b64_tr_b16 v[190:191], v11 offset:0
    v_mfma_f32_16x16x32_bf16 v[92:95], v[220:223], v[204:207], v[92:95]
    s_add_u32 s50, s50, 1
    v_mfma_f32_16x16x32_bf16 v[76:79], v[220:223], v[200:203], v[76:79]
    s_bitcmp1_b32 s51, s50
    v_mfma_f32_16x16x32_bf16 v[60:63], v[220:223], v[196:199], v[60:63]
    v_mfma_f32_16x16x32_bf16 v[44:47], v[220:223], v[192:195], v[44:47]
    s_cbranch_scc0 L_m_ktop
    s_cmp_eq_u32 s50, 16
    s_cbranch_scc1 L_m_kfin
    s_cmp_eq_u32 s50, 8
    s_cbranch_scc1 L_m_kz1
    s_nop 3
L_m_kgelu:
    v_pk_mul_f32 v[224:225], v[32:33], v[32:33]
    v_pk_mul_f32 v[226:227], v[34:35], v[34:35]
    v_pk_fma_f32 v[224:225], v[224:225], s[52:53], v[16:17]
    v_pk_fma_f32 v[226:227], v[226:227], s[52:53], v[16:17]
    v_pk_mul_f32 v[224:225], v[224:225], v[32:33]
    v_pk_mul_f32 v[226:227], v[226:227], v[34:35]
    v_pk_mul_f32 v[228:229], v[36:37], v[36:37]
    v_exp_f32 v224, v224
    v_pk_mul_f32 v[230:231], v[38:39], v[38:39]
    v_exp_f32 v225, v225
    v_pk_fma_f32 v[228:229], v[228:229], s[52:53], v[16:17]
    v_exp_f32 v226, v226
    v_pk_fma_f32 v[230:231], v[230:231], s[52:53], v[16:17]
    v_exp_f32 v227, v227
    v_pk_mul_f32 v[228:229], v[228:229], v[36:37]
    v_pk_mul_f32 v[230:231], v[230:231], v[38:39]
    v_pk_add_f32 v[224:225], v[224:225], v[18:19]
    v_exp_f32 v228, v228
    v_pk_add_f32 v[226:227], v[226:227], v[18:19]
    v_exp_f32 v229, v229
    v_pk_mul_f32 v[232:233], v[40:41], v[40:41]
    v_exp_f32 v230, v230
    v_pk_mul_f32 v[234:235], v[42:43], v[42:43]
    v_exp_f32 v231, v231
    v_pk_fma_f32 v[232:233], v[232:233], s[52:53], v[16:17]
    v_rcp_f32 v224, v224
    v_pk_fma_f32 v[234:235], v[234:235], s[52:53], v[16:17]
    v_rcp_f32 v225, v225
    v_pk_mul_f32 v[232:233], v[232:233], v[40:41]
    v_rcp_f32 v226, v226
    v_pk_mul_f32 v[234:235], v[234:235], v[42:43]
    v_rcp_f32 v227, v227
    v_pk_add_f32 v[228:229], v[228:229], v[18:19]
    v_exp_f32 v232, v232
    v_pk_add_f32 v[230:231], v[230:231], v[18:19]
    v_exp_f32 v233, v233
    v_pk_mul_f32 v[96:97], v[32:33], v[224:225]
    v_exp_f32 v234, v234
    v_pk_mul_f32 v[98:99], v[34:35], v[226:227]
    v_exp_f32 v235, v235
    v_pk_mul_f32 v[236:237], v[44:45], v[44:45]
    v_rcp_f32 v228, v228
    v_pk_mul_f32 v[238:239], v[46:47], v[46:47]
    v_rcp_f32 v229, v229
    v_pk_fma_f32 v[236:237], v[236:237], s[52:53], v[16:17]
    v_rcp_f32 v230, v230
    v_pk_fma_f32 v[238:239], v[238:239], s[52:53], v[16:17]
    v_rcp_f32 v231, v231
    v_pk_mul_f32 v[236:237], v[236:237], v[44:45]
    v_pk_mul_f32 v[238:239], v[238:239], v[46:47]
    v_pk_add_f32 v[232:233], v[232:233], v[18:19]
    v_exp_f32 v236, v236
    v_pk_add_f32 v[234:235], v[234:235], v[18:19]
    v_exp_f32 v237, v237
    v_pk_mul_f32 v[100:101], v[36:37], v[228:229]
    v_exp_f32 v238, v238
    v_pk_mul_f32 v[102:103], v[38:39], v[230:231]
    v_exp_f32 v239, v239
    v_pk_mul_f32 v[224:225], v[48:49], v[48:49]
    v_rcp_f32 v232, v232
    v_pk_mul_f32 v[226:227], v[50:51], v[50:51]
    v_rcp_f32 v233, v233
    v_pk_fma_f32 v[224:225], v[224:225], s[52:53], v[16:17]
    v_rcp_f32 v234, v234
    v_pk_fma_f32 v[226:227], v[226:227], s[52:53], v[16:17]
    v_rcp_f32 v235, v235
    v_pk_mul_f32 v[224:225], v[224:225], v[48:49]
    v_pk_mul_f32 v[226:227], v[226:227], v[50:51]
    v_pk_add_f32 v[236:237], v[236:237], v[18:19]
    v_exp_f32 v224, v224
    v_pk_add_f32 v[238:239], v[238:239], v[18:19]
    v_exp_f32 v225, v225
    v_pk_mul_f32 v[104:105], v[40:41], v[232:233]
    v_exp_f32 v226, v226
    v_pk_mul_f32 v[106:107], v[42:43], v[234:235]
    v_exp_f32 v227, v227
    v_pk_mul_f32 v[228:229], v[52:53], v[52:53]
    v_rcp_f32 v236, v236
    v_pk_mul_f32 v[230:231], v[54:55], v[54:55]
    v_rcp_f32 v237, v237
    v_pk_fma_f32 v[228:229], v[228:229], s[52:53], v[16:17]
    v_rcp_f32 v238, v238
    v_pk_fma_f32 v[230:231], v[230:231], s[52:53], v[16:17]
    v_rcp_f32 v239, v239
    v_pk_mul_f32 v[228:229], v[228:229], v[52:53]
    v_pk_mul_f32 v[230:231], v[230:231], v[54:55]
    v_pk_add_f32 v[224:225], v[224:225], v[18:19]
    v_exp_f32 v228, v228
    v_pk_add_f32 v[226:227], v[226:227], v[18:19]
    v_exp_f32 v229, v229
    v_pk_mul_f32 v[108:109], v[44:45], v[236:237]
    v_exp_f32 v230, v230
    v_pk_mul_f32 v[110:111], v[46:47], v[238:239]
    v_exp_f32 v231, v231
    v_pk_mul_f32 v[232:233], v[56:57], v[56:57]
    v_rcp_f32 v224, v224
    v_pk_mul_f32 v[234:235], v[58:59], v[58:59]
    v_rcp_f32 v225, v225
    v_pk_fma_f32 v[232:233], v[232:233], s[52:53], v[16:17]
    v_rcp_f32 v226, v226
    v_pk_fma_f32 v[234:235], v[234:235], s[52:53], v[16:17]
    v_rcp_f32 v227, v227
    v_pk_mul_f32 v[232:233], v[232:233], v[56:57]
    v_pk_mul_f32 v[234:235], v[234:235], v[58:59]
    v_pk_add_f32 v[228:229], v[228:229], v[18:19]
    v_exp_f32 v232, v232
    v_pk_add_f32 v[230:231], v[230:231], v[18:19]
    v_exp_f32 v233, v233
    v_pk_mul_f32 v[112:113], v[48:49], v[224:225]
    v_exp_f32 v234, v234
    v_pk_mul_f32 v[114:115], v[50:51], v[226:227]
    v_exp_f32 v235, v235
    v_pk_mul_f32 v[236:237], v[60:61], v[60:61]
    v_rcp_f32 v228, v228
    v_pk_mul_f32 v[238:239], v[62:63], v[62:63]
    v_rcp_f32 v229, v229
    v_pk_fma_f32 v[236:237], v[236:237], s[52:53], v[16:17]
    v_rcp_f32 v230, v230
    v_pk_fma_f32 v[238:239], v[238:239], s[52:53], v[16:17]
    v_rcp_f32 v231, v231
    v_pk_mul_f32 v[236:237], v[236:237], v[60:61]
    v_pk_mul_f32 v[238:239], v[238:239], v[62:63]
    v_pk_add_f32 v[232:233], v[232:233], v[18:19]
    v_exp_f32 v236, v236
    v_pk_add_f32 v[234:235], v[234:235], v[18:19]
    v_exp_f32 v237, v237
    v_pk_mul_f32 v[116:117], v[52:53], v[228:229]
    v_exp_f32 v238, v238
    v_pk_mul_f32 v[118:119], v[54:55], v[230:231]
    v_exp_f32 v239, v239
    v_pk_mul_f32 v[224:225], v[64:65], v[64:65]
    v_rcp_f32 v232, v232
    v_pk_mul_f32 v[226:227], v[66:67], v[66:67]
    v_rcp_f32 v233, v233
    v_pk_fma_f32 v[224:225], v[224:225], s[52:53], v[16:17]
    v_rcp_f32 v234, v234
    v_pk_fma_f32 v[226:227], v[226:227], s[52:53], v[16:17]
    v_rcp_f32 v235, v235
    v_pk_mul_f32 v[224:225], v[224:225], v[64:65]
    v_pk_mul_f32 v[226:227], v[226:227], v[66:67]
    v_pk_add_f32 v[236:237], v[236:237], v[18:19]
    v_exp_f32 v224, v224
    v_pk_add_f32 v[238:239], v[238:239], v[18:19]
    v_exp_f32 v225, v225
    v_pk_mul_f32 v[120:121], v[56:57], v[232:233]
    v_exp_f32 v226, v226
    v_pk_mul_f32 v[122:123], v[58:59], v[234:235]
    v_exp_f32 v227, v227
    v_pk_mul_f32 v[228:229], v[68:69], v[68:69]
    v_rcp_f32 v236, v236
    v_pk_mul_f32 v[230:231], v[70:71], v[70:71]
    v_rcp_f32 v237, v237
    v_pk_fma_f32 v[228:229], v[228:229], s[52:53], v[16:17]
    v_rcp_f32 v238, v238
    v_pk_fma_f32 v[230:231], v[230:231], s[52:53], v[16:17]
    v_rcp_f32 v239, v239
    v_pk_mul_f32 v[228:229], v[228:229], v[68:69]
    v_pk_mul_f32 v[230:231], v[230:231], v[70:71]
    v_pk_add_f32 v[224:225], v[224:225], v[18:19]
    v_exp_f32 v228, v228
    v_pk_add_f32 v[226:227], v[226:227], v[18:19]
    v_exp_f32 v229, v229
    v_pk_mul_f32 v[124:125], v[60:61], v[236:237]
    v_exp_f32 v230, v230
    v_pk_mul_f32 v[126:127], v[62:63], v[238:239]
    v_exp_f32 v231, v231
    v_pk_mul_f32 v[232:233], v[72:73], v[72:73]
    v_rcp_f32 v224, v224
    v_pk_mul_f32 v[234:235], v[74:75], v[74:75]
    v_rcp_f32 v225, v225
    v_pk_fma_f32 v[232:233], v[232:233], s[52:53], v[16:17]
    v_rcp_f32 v226, v226
    v_pk_fma_f32 v[234:235], v[234:235], s[52:53], v[16:17]
    v_rcp_f32 v227, v227
    v_pk_mul_f32 v[232:233], v[232:233], v[72:73]
    v_pk_mul_f32 v[234:235], v[234:235], v[74:75]
    v_pk_add_f32 v[228:229], v[228:229], v[18:19]
    v_exp_f32 v232, v232
    v_pk_add_f32 v[230:231], v[230:231], v[18:19]
    v_exp_f32 v233, v233
    v_pk_mul_f32 v[128:129], v[64:65], v[224:225]
    v_exp_f32 v234, v234
    v_pk_mul_f32 v[130:131], v[66:67], v[226:227]
    v_exp_f32 v235, v235
    v_pk_mul_f32 v[236:237], v[76:77], v[76:77]
    v_rcp_f32 v228, v228
    v_pk_mul_f32 v[238:239], v[78:79], v[78:79]
    v_rcp_f32 v229, v229
    v_pk_fma_f32 v[236:237], v[236:237], s[52:53], v[16:17]
    v_rcp_f32 v230, v230
    v_pk_fma_f32 v[238:239], v[238:239], s[52:53], v[16:17]
    v_rcp_f32 v231, v231
    v_pk_mul_f32 v[236:237], v[236:237], v[76:77]
    v_pk_mul_f32 v[238:239], v[238:239], v[78:79]
    v_pk_add_f32 v[232:233], v[232:233], v[18:19]
    v_exp_f32 v236, v236
    v_pk_add_f32 v[234:235], v[234:235], v[18:19]
    v_exp_f32 v237, v237
    v_pk_mul_f32 v[132:133], v[68:69], v[228:229]
    v_exp_f32 v238, v238
    v_pk_mul_f32 v[134:135], v[70:71], v[230:231]
    v_exp_f32 v239, v239
    v_pk_mul_f32 v[224:225], v[80:81], v[80:81]
    v_rcp_f32 v232, v232
    v_pk_mul_f32 v[226:227], v[82:83], v[82:83]
    v_rcp_f32 v233, v233
    v_pk_fma_f32 v[224:225], v[224:225], s[52:53], v[16:17]
    v_rcp_f32 v234, v234
    v_pk_fma_f32 v[226:227], v[226:227], s[52:53], v[16:17]
    v_rcp_f32 v235, v235
    v_pk_mul_f32 v[224:225], v[224:225], v[80:81]
    v_pk_mul_f32 v[226:227], v[226:227], v[82:83]
    v_pk_add_f32 v[236:237], v[236:237], v[18:19]
    v_exp_f32 v224, v224
    v_pk_add_f32 v[238:239], v[238:239], v[18:19]
    v_exp_f32 v225, v225
    v_pk_mul_f32 v[136:137], v[72:73], v[232:233]
    v_exp_f32 v226, v226
    v_pk_mul_f32 v[138:139], v[74:75], v[234:235]
    v_exp_f32 v227, v227
    v_pk_mul_f32 v[228:229], v[84:85], v[84:85]
    v_rcp_f32 v236, v236
    v_pk_mul_f32 v[230:231], v[86:87], v[86:87]
    v_rcp_f32 v237, v237
    v_pk_fma_f32 v[228:229], v[228:229], s[52:53], v[16:17]
    v_rcp_f32 v238, v238
    v_pk_fma_f32 v[230:231], v[230:231], s[52:53], v[16:17]
    v_rcp_f32 v239, v239
    v_pk_mul_f32 v[228:229], v[228:229], v[84:85]
    v_pk_mul_f32 v[230:231], v[230:231], v[86:87]
    v_pk_add_f32 v[224:225], v[224:225], v[18:19]
    v_exp_f32 v228, v228
    v_pk_add_f32 v[226:227], v[226:227], v[18:19]
    v_exp_f32 v229, v229
    v_pk_mul_f32 v[140:141], v[76:77], v[236:237]
    v_exp_f32 v230, v230
    v_pk_mul_f32 v[142:143], v[78:79], v[238:239]
    v_exp_f32 v231, v231
    v_pk_mul_f32 v[232:233], v[88:89], v[88:89]
    v_rcp_f32 v224, v224
    v_pk_mul_f32 v[234:235], v[90:91], v[90:91]
    v_rcp_f32 v225, v225
    v_pk_fma_f32 v[232:233], v[232:233], s[52:53], v[16:17]
    v_rcp_f32 v226, v226
    v_pk_fma_f32 v[234:235], v[234:235], s[52:53], v[16:17]
    v_rcp_f32 v227, v227
    v_pk_mul_f32 v[232:233], v[232:233], v[88:89]
    v_pk_mul_f32 v[234:235], v[234:235], v[90:91]
    v_pk_add_f32 v[228:229], v[228:229], v[18:19]
    v_exp_f32 v232, v232
    v_pk_add_f32 v[230:231], v[230:231], v[18:19]
    v_exp_f32 v233, v233
    v_pk_mul_f32 v[144:145], v[80:81], v[224:225]
    v_exp_f32 v234, v234
    v_pk_mul_f32 v[146:147], v[82:83], v[226:227]
    v_exp_f32 v235, v235
    v_pk_mul_f32 v[236:237], v[92:93], v[92:93]
    v_rcp_f32 v228, v228
    v_pk_mul_f32 v[238:239], v[94:95], v[94:95]
    v_rcp_f32 v229, v229
    v_pk_fma_f32 v[236:237], v[236:237], s[52:53], v[16:17]
    v_rcp_f32 v230, v230
    v_pk_fma_f32 v[238:239], v[238:239], s[52:53], v[16:17]
    v_rcp_f32 v231, v231
    v_pk_mul_f32 v[236:237], v[236:237], v[92:93]
    v_pk_mul_f32 v[238:239], v[238:239], v[94:95]
    v_pk_add_f32 v[232:233], v[232:233], v[18:19]
    v_exp_f32 v236, v236
    v_pk_add_f32 v[234:235], v[234:235], v[18:19]
    v_exp_f32 v237, v237
    v_pk_mul_f32 v[148:149], v[84:85], v[228:229]
    v_exp_f32 v238, v238
    v_pk_mul_f32 v[150:151], v[86:87], v[230:231]
    v_exp_f32 v239, v239
    v_rcp_f32 v232, v232
    v_rcp_f32 v233, v233
    v_rcp_f32 v234, v234
    v_rcp_f32 v235, v235
    s_nop 0
    v_pk_add_f32 v[236:237], v[236:237], v[18:19]
    v_pk_add_f32 v[238:239], v[238:239], v[18:19]
    v_rcp_f32 v236, v236
    v_rcp_f32 v237, v237
    v_pk_mul_f32 v[152:153], v[88:89], v[232:233]
    v_rcp_f32 v238, v238
    v_pk_mul_f32 v[154:155], v[90:91], v[234:235]
    v_rcp_f32 v239, v239
    s_nop 0
    v_pk_mul_f32 v[156:157], v[92:93], v[236:237]
    v_pk_mul_f32 v[158:159], v[94:95], v[238:239]
    s_nop 0
    s_cmp_eq_u32 s50, 8
    s_cbranch_scc1 L_m_kz1b
    v_pk_add_f32 v[20:21], v[96:97], v[98:99]
    v_pk_mul_f32 v[22:23], v[96:97], v[96:97]
    v_pk_add_f32 v[24:25], v[100:101], v[102:103]
    v_pk_mul_f32 v[26:27], v[98:99], v[98:99]
    v_pk_fma_f32 v[22:23], v[100:101], v[100:101], v[22:23]
    v_pk_fma_f32 v[26:27], v[102:103], v[102:103], v[26:27]
    v_pk_fma_f32 v[22:23], v[104:105], v[104:105], v[22:23]
    v_pk_fma_f32 v[26:27], v[106:107], v[106:107], v[26:27]
    v_pk_fma_f32 v[22:23], v[108:109], v[108:109], v[22:23]
    v_pk_fma_f32 v[26:27], v[110:111], v[110:111], v[26:27]
    v_pk_add_f32 v[20:21], v[20:21], v[104:105]
    v_pk_add_f32 v[24:25], v[24:25], v[106:107]
    v_pk_add_f32 v[20:21], v[20:21], v[108:109]
    v_pk_add_f32 v[24:25], v[24:25], v[110:111]
    v_pk_add_f32 v[20:21], v[20:21], v[24:25]
    v_pk_add_f32 v[22:23], v[22:23], v[26:27]
    v_add_f32 v240, v20, v21
    v_add_f32 v244, v22, v23
    v_pk_add_f32 v[20:21], v[112:113], v[114:115]
    v_pk_mul_f32 v[22:23], v[112:113], v[112:113]
    v_pk_add_f32 v[24:25], v[116:117], v[118:119]
    v_pk_mul_f32 v[26:27], v[114:115], v[114:115]
    v_pk_fma_f32 v[22:23], v[116:117], v[116:117], v[22:23]
    v_pk_fma_f32 v[26:27], v[118:119], v[118:119], v[26:27]
    v_pk_fma_f32 v[22:23], v[120:121], v[120:121], v[22:23]
    v_pk_fma_f32 v[26:27], v[122:123], v[122:123], v[26:27]
    v_pk_fma_f32 v[22:23], v[124:125], v[124:125], v[22:23]
    v_pk_fma_f32 v[26:27], v[126:127], v[126:127], v[26:27]
    v_pk_add_f32 v[20:21], v[20:21], v[120:121]
    v_pk_add_f32 v[24:25], v[24:25], v[122:123]
    v_pk_add_f32 v[20:21], v[20:21], v[124:125]
    v_pk_add_f32 v[24:25], v[24:25], v[126:127]
    v_pk_add_f32 v[20:21], v[20:21], v[24:25]
    v_pk_add_f32 v[22:23], v[22:23], v[26:27]
    v_add_f32 v241, v20, v21
    v_add_f32 v245, v22, v23
    v_pk_add_f32 v[20:21], v[128:129], v[130:131]
    v_pk_mul_f32 v[22:23], v[128:129], v[128:129]
    v_pk_add_f32 v[24:25], v[132:133], v[134:135]
    v_pk_mul_f32 v[26:27], v[130:131], v[130:131]
    v_pk_fma_f32 v[22:23], v[132:133], v[132:133], v[22:23]
    v_pk_fma_f32 v[26:27], v[134:135], v[134:135], v[26:27]
    v_pk_fma_f32 v[22:23], v[136:137], v[136:137], v[22:23]
    v_pk_fma_f32 v[26:27], v[138:139], v[138:139], v[26:27]
    v_pk_fma_f32 v[22:23], v[140:141], v[140:141], v[22:23]
    v_pk_fma_f32 v[26:27], v[142:143], v[142:143], v[26:27]
    v_pk_add_f32 v[20:21], v[20:21], v[136:137]
    v_pk_add_f32 v[24:25], v[24:25], v[138:139]
    v_pk_add_f32 v[20:21], v[20:21], v[140:141]
    v_pk_add_f32 v[24:25], v[24:25], v[142:143]
    v_pk_add_f32 v[20:21], v[20:21], v[24:25]
    v_pk_add_f32 v[22:23], v[22:23], v[26:27]
    v_add_f32 v242, v20, v21
    v_add_f32 v246, v22, v23
    v_pk_add_f32 v[20:21], v[144:145], v[146:147]
    v_pk_mul_f32 v[22:23], v[144:145], v[144:145]
    v_pk_add_f32 v[24:25], v[148:149], v[150:151]
    v_pk_mul_f32 v[26:27], v[146:147], v[146:147]
    v_pk_fma_f32 v[22:23], v[148:149], v[148:149], v[22:23]
    v_pk_fma_f32 v[26:27], v[150:151], v[150:151], v[26:27]
    v_pk_fma_f32 v[22:23], v[152:153], v[152:153], v[22:23]
    v_pk_fma_f32 v[26:27], v[154:155], v[154:155], v[26:27]
    v_pk_fma_f32 v[22:23], v[156:157], v[156:157], v[22:23]
    v_pk_fma_f32 v[26:27], v[158:159], v[158:159], v[26:27]
    v_pk_add_f32 v[20:21], v[20:21], v[152:153]
    v_pk_add_f32 v[24:25], v[24:25], v[154:155]
    v_pk_add_f32 v[20:21], v[20:21], v[156:157]
    v_pk_add_f32 v[24:25], v[24:25], v[158:159]
    v_pk_add_f32 v[20:21], v[20:21], v[24:25]
    v_pk_add_f32 v[22:23], v[22:23], v[26:27]
    v_add_f32 v243, v20, v21
    v_add_f32 v247, v22, v23
    s_nop 1
    v_permlane32_swap_b32 v240, v242
    v_permlane32_swap_b32 v241, v243
    v_permlane32_swap_b32 v244, v246
    v_permlane32_swap_b32 v245, v247
    v_add_f32 v240, v240, v242
    v_add_f32 v241, v241, v243
    v_add_f32 v244, v244, v246
    v_add_f32 v245, v245, v247
    s_nop 0
    v_permlane16_swap_b32 v240, v241
    v_permlane16_swap_b32 v244, v245
    v_add_f32 v240, v240, v241
    v_add_f32 v241, v244, v245
    ds_write_b64 v14, v[240:241]
    s_waitcnt lgkmcnt(0)
    s_branch L_m_kfirst
L_m_kz1:
    s_branch L_m_kgelu
L_m_kz1b:
    s_waitcnt vmcnt(0)
    v_lshlrev_b32 v224, 16, v240
    v_lshlrev_b32 v225, 16, v240
    v_lshlrev_b32 v226, 16, v240
    v_lshlrev_b32 v227, 16, v240
    v_lshlrev_b32 v228, 16, v241
    v_lshlrev_b32 v229, 16, v241
    v_lshlrev_b32 v230, 16, v241
    v_lshlrev_b32 v231, 16, v241
    v_lshlrev_b32 v232, 16, v242
    v_lshlrev_b32 v233, 16, v242
    v_lshlrev_b32 v234, 16, v242
    v_lshlrev_b32 v235, 16, v242
    v_lshlrev_b32 v236, 16, v243
    v_lshlrev_b32 v237, 16, v243
    v_lshlrev_b32 v238, 16, v243
    v_lshlrev_b32 v239, 16, v243
    s_nop 1
    s_waitcnt lgkmcnt(9)
    v_mfma_f32_16x16x32_bf16 v[32:35], v[176:179], v[160:163], v[224:227]
    ds_read_b128 v[192:195], v3 offset:0
    s_waitcnt lgkmcnt(9)
    v_mfma_f32_16x16x32_bf16 v[48:51], v[176:179], v[164:167], v[228:231]
    ds_read_b64_tr_b16 v[208:209], v4 offset:8192
    s_waitcnt lgkmcnt(9)
    v_mfma_f32_16x16x32_bf16 v[64:67], v[176:179], v[168:171], v[232:235]
    ds_read_b64_tr_b16 v[210:211], v5 offset:8192
    s_waitcnt lgkmcnt(9)
    v_mfma_f32_16x16x32_bf16 v[80:83], v[176:179], v[172:175], v[236:239]
    ds_read_b128 v[196:199], v3 offset:2048
    s_waitcnt lgkmcnt(8)
    v_mfma_f32_16x16x32_bf16 v[84:87], v[180:183], v[172:175], v[236:239]
    ds_read_b128 v[200:203], v3 offset:4096
    v_mfma_f32_16x16x32_bf16 v[68:71], v[180:183], v[168:171], v[232:235]
    ds_read_b128 v[204:207], v3 offset:6144
    v_mfma_f32_16x16x32_bf16 v[52:55], v[180:183], v[164:167], v[228:231]
    ds_read_b64_tr_b16 v[212:213], v6 offset:8192
    v_mfma_f32_16x16x32_bf16 v[36:39], v[180:183], v[160:163], v[224:227]
    ds_read_b64_tr_b16 v[214:215], v7 offset:8192
    s_waitcnt lgkmcnt(10)
    v_mfma_f32_16x16x32_bf16 v[40:43], v[184:187], v[160:163], v[224:227]
    ds_read_b64_tr_b16 v[216:217], v8 offset:8192
    v_mfma_f32_16x16x32_bf16 v[56:59], v[184:187], v[164:167], v[228:231]
    ds_read_b64_tr_b16 v[218:219], v9 offset:8192
    v_mfma_f32_16x16x32_bf16 v[72:75], v[184:187], v[168:171], v[232:235]
    ds_read_b64_tr_b16 v[220:221], v10 offset:8192
    v_mfma_f32_16x16x32_bf16 v[88:91], v[184:187], v[172:175], v[236:239]
    ds_read_b64_tr_b16 v[222:223], v11 offset:8192
    s_waitcnt lgkmcnt(12)
    v_mfma_f32_16x16x32_bf16 v[92:95], v[188:191], v[172:175], v[236:239]
    v_mfma_f32_16x16x32_bf16 v[76:79], v[188:191], v[168:171], v[232:235]
    v_mfma_f32_16x16x32_bf16 v[60:63], v[188:191], v[164:167], v[228:231]
    v_mfma_f32_16x16x32_bf16 v[44:47], v[188:191], v[160:163], v[224:227]
    s_branch L_m_kmid
L_m_ksw:
    v_add_u32 v4, 0, v12
    v_add_u32 v5, 0, v13
    v_add_u32 v6, 1024, v12
    v_add_u32 v7, 1024, v13
    v_add_u32 v8, 2048, v12
    v_add_u32 v9, 2048, v13
    v_add_u32 v10, 3072, v12
    v_add_u32 v11, 3072, v13
    s_branch L_m_kswr
L_m_knorm:
    s_cmp_lg_u32 s50, 5
    s_cbranch_scc1 L_m_ev28
    ds_read_b64 v[20:21], v15 offset:0
    ds_read_b64 v[22:23], v15 offset:128
    ds_read_b64 v[24:25], v15 offset:256
    ds_read_b64 v[26:27], v15 offset:384
    s_waitcnt lgkmcnt(0)
    v_pk_fma_f32 v[96:97], v[96:97], v[20:21], v[20:21] op_sel:[0,0,1] op_sel_hi:[1,0,1]
    v_pk_fma_f32 v[98:99], v[98:99], v[20:21], v[20:21] op_sel:[0,0,1] op_sel_hi:[1,0,1]
    v_pk_fma_f32 v[112:113], v[112:113], v[22:23], v[22:23] op_sel:[0,0,1] op_sel_hi:[1,0,1]
    v_pk_fma_f32 v[114:115], v[114:115], v[22:23], v[22:23] op_sel:[0,0,1] op_sel_hi:[1,0,1]
    v_cvt_pk_bf16_f32 v224, v96, v97
    v_cvt_pk_bf16_f32 v225, v98, v99
    v_cvt_pk_bf16_f32 v226, v112, v113
    v_cvt_pk_bf16_f32 v227, v114, v115
    v_pk_fma_f32 v[100:101], v[100:101], v[20:21], v[20:21] op_sel:[0,0,1] op_sel_hi:[1,0,1]
    v_pk_fma_f32 v[102:103], v[102:103], v[20:21], v[20:21] op_sel:[0,0,1] op_sel_hi:[1,0,1]
    v_pk_fma_f32 v[116:117], v[116:117], v[22:23], v[22:23] op_sel:[0,0,1] op_sel_hi:[1,0,1]
    v_pk_fma_f32 v[118:119], v[118:119], v[22:23], v[22:23] op_sel:[0,0,1] op_sel_hi:[1,0,1]
    v_cvt_pk_bf16_f32 v228, v100, v101
    v_cvt_pk_bf16_f32 v229, v102, v103
    v_cvt_pk_bf16_f32 v230, v116, v117
    v_cvt_pk_bf16_f32 v231, v118, v119
    v_permlane16_swap_b32 v224, v226
    v_permlane16_swap_b32 v225, v227
    buffer_store_dwordx4 v[224:227], v28, s[32:35], 0 offen offset:0 sc1
    v_pk_fma_f32 v[104:105], v[104:105], v[20:21], v[20:21] op_sel:[0,0,1] op_sel_hi:[1,0,1]
    v_pk_fma_f32 v[106:107], v[106:107], v[20:21], v[20:21] op_sel:[0,0,1] op_sel_hi:[1,0,1]
    v_pk_fma_f32 v[120:121], v[120:121], v[22:23], v[22:23] op_sel:[0,0,1] op_sel_hi:[1,0,1]
    v_pk_fma_f32 v[122:123], v[122:123], v[22:23], v[22:23] op_sel:[0,0,1] op_sel_hi:[1,0,1]
    v_cvt_pk_bf16_f32 v232, v104, v105
    v_cvt_pk_bf16_f32 v233, v106, v107
    v_cvt_pk_bf16_f32 v234, v120, v121
    v_cvt_pk_bf16_f32 v235, v122, v123
    v_permlane16_swap_b32 v228, v230
    v_permlane16_swap_b32 v229, v231
    buffer_store_dwordx4 v[228:231], v28, s[32:35], 0 offen offset:1024 sc1
    v_pk_fma_f32 v[108:109], v[108:109], v[20:21], v[20:21] op_sel:[0,0,1] op_sel_hi:[1,0,1]
    v_pk_fma_f32 v[110:111], v[110:111], v[20:21], v[20:21] op_sel:[0,0,1] op_sel_hi:[1,0,1]
    v_pk_fma_f32 v[124:125], v[124:125], v[22:23], v[22:23] op_sel:[0,0,1] op_sel_hi:[1,0,1]
    v_pk_fma_f32 v[126:127], v[126:127], v[22:23], v[22:23] op_sel:[0,0,1] op_sel_hi:[1,0,1]
    v_cvt_pk_bf16_f32 v236, v108, v109
    v_cvt_pk_bf16_f32 v237, v110, v111
    v_cvt_pk_bf16_f32 v238, v124, v125
    v_cvt_pk_bf16_f32 v239, v126, v127
    v_permlane16_swap_b32 v232, v234
    v_permlane16_swap_b32 v233, v235
    buffer_store_dwordx4 v[232:235], v28, s[32:35], 0 offen offset:2048 sc1
    v_pk_fma_f32 v[128:129], v[128:129], v[24:25], v[24:25] op_sel:[0,0,1] op_sel_hi:[1,0,1]
    v_pk_fma_f32 v[130:131], v[130:131], v[24:25], v[24:25] op_sel:[0,0,1] op_sel_hi:[1,0,1]
    v_pk_fma_f32 v[144:145], v[144:145], v[26:27], v[26:27] op_sel:[0,0,1] op_sel_hi:[1,0,1]
    v_pk_fma_f32 v[146:147], v[146:147], v[26:27], v[26:27] op_sel:[0,0,1] op_sel_hi:[1,0,1]
    v_cvt_pk_bf16_f32 v240, v128, v129
    v_cvt_pk_bf16_f32 v241, v130, v131
    v_cvt_pk_bf16_f32 v242, v144, v145
    v_cvt_pk_bf16_f32 v243, v146, v147
    v_permlane16_swap_b32 v236, v238
    v_permlane16_swap_b32 v237, v239
    buffer_store_dwordx4 v[236:239], v28, s[32:35], 0 offen offset:3072 sc1
    v_pk_fma_f32 v[132:133], v[132:133], v[24:25], v[24:25] op_sel:[0,0,1] op_sel_hi:[1,0,1]
    v_pk_fma_f32 v[134:135], v[134:135], v[24:25], v[24:25] op_sel:[0,0,1] op_sel_hi:[1,0,1]
    v_pk_fma_f32 v[148:149], v[148:149], v[26:27], v[26:27] op_sel:[0,0,1] op_sel_hi:[1,0,1]
    v_pk_fma_f32 v[150:151], v[150:151], v[26:27], v[26:27] op_sel:[0,0,1] op_sel_hi:[1,0,1]
    v_cvt_pk_bf16_f32 v244, v132, v133
    v_cvt_pk_bf16_f32 v245, v134, v135
    v_cvt_pk_bf16_f32 v246, v148, v149
    v_cvt_pk_bf16_f32 v247, v150, v151
    v_permlane16_swap_b32 v240, v242
    v_permlane16_swap_b32 v241, v243
    buffer_store_dwordx4 v[240:243], v28, s[32:35], s54 offen offset:0 sc1
    v_pk_fma_f32 v[136:137], v[136:137], v[24:25], v[24:25] op_sel:[0,0,1] op_sel_hi:[1,0,1]
    v_pk_fma_f32 v[138:139], v[138:139], v[24:25], v[24:25] op_sel:[0,0,1] op_sel_hi:[1,0,1]
    v_pk_fma_f32 v[152:153], v[152:153], v[26:27], v[26:27] op_sel:[0,0,1] op_sel_hi:[1,0,1]
    v_pk_fma_f32 v[154:155], v[154:155], v[26:27], v[26:27] op_sel:[0,0,1] op_sel_hi:[1,0,1]
    v_cvt_pk_bf16_f32 v248, v136, v137
    v_cvt_pk_bf16_f32 v249, v138, v139
    v_cvt_pk_bf16_f32 v250, v152, v153
    v_cvt_pk_bf16_f32 v251, v154, v155
    v_permlane16_swap_b32 v244, v246
    v_permlane16_swap_b32 v245, v247
    buffer_store_dwordx4 v[244:247], v28, s[32:35], s54 offen offset:1024 sc1
    v_pk_fma_f32 v[140:141], v[140:141], v[24:25], v[24:25] op_sel:[0,0,1] op_sel_hi:[1,0,1]
    v_pk_fma_f32 v[142:143], v[142:143], v[24:25], v[24:25] op_sel:[0,0,1] op_sel_hi:[1,0,1]
    v_pk_fma_f32 v[156:157], v[156:157], v[26:27], v[26:27] op_sel:[0,0,1] op_sel_hi:[1,0,1]
    v_pk_fma_f32 v[158:159], v[158:159], v[26:27], v[26:27] op_sel:[0,0,1] op_sel_hi:[1,0,1]
    v_cvt_pk_bf16_f32 v252, v140, v141
    v_cvt_pk_bf16_f32 v253, v142, v143
    v_cvt_pk_bf16_f32 v254, v156, v157
    v_cvt_pk_bf16_f32 v255, v158, v159
    v_permlane16_swap_b32 v248, v250
    v_permlane16_swap_b32 v249, v251
    buffer_store_dwordx4 v[248:251], v28, s[32:35], s54 offen offset:2048 sc1
    s_nop 1
    v_permlane16_swap_b32 v252, v254
    v_permlane16_swap_b32 v253, v255
    buffer_store_dwordx4 v[252:255], v28, s[32:35], s54 offen offset:3072 sc1
    s_branch L_m_knormr
L_m_ev28:
    buffer_load_ushort v240, v30, s[36:39], 0 offen offset:0
    buffer_load_ushort v241, v30, s[36:39], 0 offen offset:32
    buffer_load_ushort v242, v30, s[36:39], 0 offen offset:64
    buffer_load_ushort v243, v30, s[36:39], 0 offen offset:96
    s_branch L_m_knormr
L_m_kfin:
    s_lshl_b32 s3, s49, 14
    s_lshl_b32 s19, s48, 12
    s_add_u32 s3, s3, s19
    v_lshl_add_u32 v12, v1, 4, s3
    s_waitcnt lgkmcnt(0)
    s_nop 5
    v_pk_mul_f32 v[32:33], v[32:33], v[96:97]
    v_pk_mul_f32 v[34:35], v[34:35], v[98:99]
    v_pk_mul_f32 v[36:37], v[36:37], v[100:101]
    v_pk_mul_f32 v[38:39], v[38:39], v[102:103]
    v_cvt_pk_bf16_f32 v160, v32, v33
    v_cvt_pk_bf16_f32 v161, v34, v35
    v_cvt_pk_bf16_f32 v162, v36, v37
    v_cvt_pk_bf16_f32 v163, v38, v39
    buffer_store_dwordx4 v[160:163], v29, s[40:43], 0 offen offset:0 sc1
    ds_write_b128 v12, v[160:163] offset:0
    v_pk_mul_f32 v[48:49], v[48:49], v[112:113]
    v_pk_mul_f32 v[50:51], v[50:51], v[114:115]
    v_pk_mul_f32 v[52:53], v[52:53], v[116:117]
    v_pk_mul_f32 v[54:55], v[54:55], v[118:119]
    v_cvt_pk_bf16_f32 v164, v48, v49
    v_cvt_pk_bf16_f32 v165, v50, v51
    v_cvt_pk_bf16_f32 v166, v52, v53
    v_cvt_pk_bf16_f32 v167, v54, v55
    buffer_store_dwordx4 v[164:167], v29, s[40:43], 0 offen offset:1024 sc1
    ds_write_b128 v12, v[164:167] offset:1024
    v_pk_mul_f32 v[64:65], v[64:65], v[128:129]
    v_pk_mul_f32 v[66:67], v[66:67], v[130:131]
    v_pk_mul_f32 v[68:69], v[68:69], v[132:133]
    v_pk_mul_f32 v[70:71], v[70:71], v[134:135]
    v_cvt_pk_bf16_f32 v168, v64, v65
    v_cvt_pk_bf16_f32 v169, v66, v67
    v_cvt_pk_bf16_f32 v170, v68, v69
    v_cvt_pk_bf16_f32 v171, v70, v71
    buffer_store_dwordx4 v[168:171], v29, s[40:43], 0 offen offset:2048 sc1
    ds_write_b128 v12, v[168:171] offset:2048
    v_pk_mul_f32 v[80:81], v[80:81], v[144:145]
    v_pk_mul_f32 v[82:83], v[82:83], v[146:147]
    v_pk_mul_f32 v[84:85], v[84:85], v[148:149]
    v_pk_mul_f32 v[86:87], v[86:87], v[150:151]
    v_cvt_pk_bf16_f32 v172, v80, v81
    v_cvt_pk_bf16_f32 v173, v82, v83
    v_cvt_pk_bf16_f32 v174, v84, v85
    v_cvt_pk_bf16_f32 v175, v86, v87
    buffer_store_dwordx4 v[172:175], v29, s[40:43], 0 offen offset:3072 sc1
    ds_write_b128 v12, v[172:175] offset:3072
    v_pk_mul_f32 v[40:41], v[40:41], v[104:105]
    v_pk_mul_f32 v[42:43], v[42:43], v[106:107]
    v_pk_mul_f32 v[44:45], v[44:45], v[108:109]
    v_pk_mul_f32 v[46:47], v[46:47], v[110:111]
    v_cvt_pk_bf16_f32 v176, v40, v41
    v_cvt_pk_bf16_f32 v177, v42, v43
    v_cvt_pk_bf16_f32 v178, v44, v45
    v_cvt_pk_bf16_f32 v179, v46, v47
    buffer_store_dwordx4 v[176:179], v29, s[40:43], s54 offen offset:0 sc1
    ds_write_b128 v12, v[176:179] offset:8192
    v_pk_mul_f32 v[56:57], v[56:57], v[120:121]
    v_pk_mul_f32 v[58:59], v[58:59], v[122:123]
    v_pk_mul_f32 v[60:61], v[60:61], v[124:125]
    v_pk_mul_f32 v[62:63], v[62:63], v[126:127]
    v_cvt_pk_bf16_f32 v180, v56, v57
    v_cvt_pk_bf16_f32 v181, v58, v59
    v_cvt_pk_bf16_f32 v182, v60, v61
    v_cvt_pk_bf16_f32 v183, v62, v63
    buffer_store_dwordx4 v[180:183], v29, s[40:43], s54 offen offset:1024 sc1
    ds_write_b128 v12, v[180:183] offset:9216
    v_pk_mul_f32 v[72:73], v[72:73], v[136:137]
    v_pk_mul_f32 v[74:75], v[74:75], v[138:139]
    v_pk_mul_f32 v[76:77], v[76:77], v[140:141]
    v_pk_mul_f32 v[78:79], v[78:79], v[142:143]
    v_cvt_pk_bf16_f32 v184, v72, v73
    v_cvt_pk_bf16_f32 v185, v74, v75
    v_cvt_pk_bf16_f32 v186, v76, v77
    v_cvt_pk_bf16_f32 v187, v78, v79
    buffer_store_dwordx4 v[184:187], v29, s[40:43], s54 offen offset:2048 sc1
    ds_write_b128 v12, v[184:187] offset:10240
    v_pk_mul_f32 v[88:89], v[88:89], v[152:153]
    v_pk_mul_f32 v[90:91], v[90:91], v[154:155]
    v_pk_mul_f32 v[92:93], v[92:93], v[156:157]
    v_pk_mul_f32 v[94:95], v[94:95], v[158:159]
    v_cvt_pk_bf16_f32 v188, v88, v89
    v_cvt_pk_bf16_f32 v189, v90, v91
    v_cvt_pk_bf16_f32 v190, v92, v93
    v_cvt_pk_bf16_f32 v191, v94, v95
    buffer_store_dwordx4 v[188:191], v29, s[40:43], s54 offen offset:3072 sc1
    ds_write_b128 v12, v[188:191] offset:11264
    s_mov_b32 s51, 0
    s_branch L_m_cg3
L_m_cspare:
    s_mov_b32 s20, s78
    s_mov_b32 s21, s79
    s_mov_b32 s22, 7340032
    s_mov_b32 s23, 0x20000
    s_mov_b32 s24, s80
    s_mov_b32 s25, s81
    s_mov_b32 s26, 8388608
    s_mov_b32 s27, 0x20000
    s_mov_b32 s28, s84
    s_mov_b32 s29, s85
    s_mov_b32 s30, 3670016
    s_mov_b32 s31, 0x20000
    s_sub_u32 s3, s17, 28
    s_lshl_b32 s3, s3, 3
    s_add_u32 s48, s3, s18
    s_lshl_b32 s3, s48, 4
    v_lshrrev_b32 v2, 2, v1
    v_add_u32 v2, s3, v2
    v_mul_u32_u24 v2, 7168, v2
    v_and_b32 v3, 3, v1
    v_lshl_add_u32 v2, v3, 9, v2
    s_and_b32 s3, s16, 1
    s_mul_i32 s3, s3, 1536
    s_add_u32 s49, s3, 384
    s_add_u32 s3, s49, 3584
    buffer_load_dword v10, v2, s[20:23], s3 offen
    s_add_u32 s3, s49, 3673600
    buffer_load_dword v10, v2, s[20:23], s3 offen
    s_add_u32 s3, s49, 0
    buffer_load_dword v10, v2, s[20:23], s3 offen
    s_add_u32 s3, s49, 3670016
    buffer_load_dword v10, v2, s[20:23], s3 offen
    s_cmp_ge_u32 s18, 2
    s_cbranch_scc1 L_m_ss29
    s_sub_u32 s3, s17, 28
    s_lshl_b32 s19, s16, 2
    s_add_u32 s3, s3, s19
    s_mul_i32 s3, s3, 2
    s_add_u32 s48, s3, s18
    s_lshl_b32 s3, s48, 6
    v_add_u32 v2, s3, v1
    s_mov_b32 s49, 9363
    v_mov_b32 v3, v2
    s_mov_b32 s50, 7
L_m_sl30:
    v_lshrrev_b32 v4, 2, v3
    v_mul_u32_u24 v4, s49, v4
    v_lshrrev_b32 v4, 16, v4
    v_mul_u32_u24 v5, 28, v4
    v_sub_u32 v5, v3, v5
    v_mul_u32_u24 v4, 7168, v4
    v_lshl_add_u32 v5, v5, 7, v4
    buffer_load_dword v10, v5, s[20:23], 0 offen
    v_add_u32 v3, 4096, v3
    s_waitcnt vmcnt(0)
    s_sub_u32 s50, s50, 1
    s_cmp_lg_u32 s50, 0
    s_cbranch_scc1 L_m_sl30
    v_mov_b32 v3, v2
    s_mov_b32 s50, 16
L_m_sl31:
    v_and_b32 v4, 2047, v3
    v_lshrrev_b32 v5, 11, v3
    v_lshlrev_b32 v4, 12, v4
    v_lshl_add_u32 v5, v5, 7, v4
    buffer_load_dword v10, v5, s[24:27], 0 offen
    v_add_u32 v3, 4096, v3
    s_waitcnt vmcnt(0)
    s_sub_u32 s50, s50, 1
    s_cmp_lg_u32 s50, 0
    s_cbranch_scc1 L_m_sl31
L_m_ss29:
    s_waitcnt vmcnt(0)
    s_barrier
    s_mov_b32 s51, 32768
L_m_cg3:
    s_mov_b32 s24, s90
    s_mov_b32 s25, s91
    s_mov_b32 s26, 4194304
    s_mov_b32 s27, 0x20000
    s_add_u32 s32, s94, 25165824
    s_addc_u32 s33, s95, 0
    s_mov_b32 s34, 4194304
    s_mov_b32 s35, 0x20000
    s_add_u32 s36, s94, 8912896
    s_addc_u32 s37, s95, 0
    s_mov_b32 s38, 12288
    s_mov_b32 s39, 0x20000
    v_lshrrev_b32 v110, 3, v0
    v_and_b32 v111, 7, v0
    s_lshl_b32 s3, s12, 18
    s_lshl_b32 s19, s14, 7
    s_add_u32 s3, s3, s19
    v_lshlrev_b32 v112, 4, v111
    v_lshl_add_u32 v113, v110, 11, v112
    v_add_u32 v120, s3, v113
    s_add_u32 s19, s19, 10240
    v_add_u32 v121, s19, v112
    v_and_b32 v112, 7, v110
    v_xor_b32 v112, v112, v111
    v_lshlrev_b32 v112, 4, v112
    v_lshl_add_u32 v122, v110, 7, v112
    s_mov_b32 s9, 131072
    v_and_b32 v10, 15, v1
    v_lshrrev_b32 v11, 4, v1
    v_bfe_u32 v12, v1, 2, 2
    v_and_b32 v13, 3, v1
    s_lshl_b32 s3, s18, 11
    v_lshl_add_u32 v2, v1, 4, s3
    v_lshl_add_u32 v14, v11, 2, v12
    v_bfe_u32 v15, v14, 1, 2
    v_lshlrev_b32 v14, 7, v14
    v_lshl_add_u32 v14, v13, 3, v14
    v_add_u32 v14, 131072, v14
    s_mov_b32 s51, -65536
    s_mov_b32 s52, 3
    v_xor_b32 v9, 0, v15
    v_lshl_add_u32 v4, v9, 5, v14
    v_xor_b32 v9, 1, v15
    v_lshl_add_u32 v5, v9, 5, v14
    v_xor_b32 v9, 2, v15
    v_lshl_add_u32 v6, v9, 5, v14
    v_xor_b32 v9, 3, v15
    v_lshl_add_u32 v7, v9, 5, v14
    v_lshrrev_b32 v14, 1, v11
    v_and_b32 v15, 7, v10
    v_xor_b32 v14, v14, v15
    v_lshlrev_b32 v14, 4, v14
    v_and_b32 v15, 1, v11
    v_lshl_add_u32 v14, v15, 3, v14
    v_lshl_add_u32 v14, v10, 7, v14
    s_lshl_b32 s3, s18, 12
    s_add_u32 s3, s3, 65536
    v_add_u32 v8, s3, v14
    v_mov_b32 v16, 0
    v_mov_b32 v17, 0
    v_mov_b32 v18, 0
    v_mov_b32 v19, 0
    v_mov_b32 v20, 0
    v_mov_b32 v21, 0
    v_mov_b32 v22, 0
    v_mov_b32 v23, 0
    v_mov_b32 v24, 0
    v_mov_b32 v25, 0
    v_mov_b32 v26, 0
    v_mov_b32 v27, 0
    v_mov_b32 v28, 0
    v_mov_b32 v29, 0
    v_mov_b32 v30, 0
    v_mov_b32 v31, 0
    v_mov_b32 v32, 0
    v_mov_b32 v33, 0
    v_mov_b32 v34, 0
    v_mov_b32 v35, 0
    v_mov_b32 v36, 0
    v_mov_b32 v37, 0
    v_mov_b32 v38, 0
    v_mov_b32 v39, 0
    v_mov_b32 v40, 0
    v_mov_b32 v41, 0
    v_mov_b32 v42, 0
    v_mov_b32 v43, 0
    v_mov_b32 v44, 0
    v_mov_b32 v45, 0
    v_mov_b32 v46, 0
    v_mov_b32 v47, 0
    s_mov_b32 s50, 7
    s_waitcnt lgkmcnt(0)
    s_barrier
    ds_read_b128 v[48:51], v2 offset:0
    ds_read_b64_tr_b16 v[56:57], v4 offset:0
    ds_read_b64_tr_b16 v[58:59], v4 offset:2048
    ds_read_b128 v[52:55], v2 offset:1024
    ds_read_b64_tr_b16 v[60:61], v5 offset:0
    ds_read_b64_tr_b16 v[62:63], v5 offset:2048
    ds_read_b64_tr_b16 v[64:65], v6 offset:0
    ds_read_b64_tr_b16 v[66:67], v6 offset:2048
    ds_read_b64_tr_b16 v[68:69], v7 offset:0
    ds_read_b64_tr_b16 v[70:71], v7 offset:2048
L_m_cl32:
    s_waitcnt lgkmcnt(7)
    v_mfma_f32_16x16x32_bf16 v[16:19], v[56:59], v[48:51], v[16:19]
    ds_read_b128 v[72:75], v2 offset:8192
    ds_read_b64_tr_b16 v[80:81], v4 offset:4096
    s_waitcnt lgkmcnt(8)
    v_mfma_f32_16x16x32_bf16 v[32:35], v[56:59], v[52:55], v[32:35]
    ds_read_b64_tr_b16 v[82:83], v4 offset:6144
    ds_read_b128 v[76:79], v2 offset:9216
    s_waitcnt lgkmcnt(8)
    v_mfma_f32_16x16x32_bf16 v[36:39], v[60:63], v[52:55], v[36:39]
    ds_read_b64_tr_b16 v[84:85], v5 offset:4096
    v_mfma_f32_16x16x32_bf16 v[20:23], v[60:63], v[48:51], v[20:23]
    ds_read_b64_tr_b16 v[86:87], v5 offset:6144
    s_waitcnt lgkmcnt(8)
    v_mfma_f32_16x16x32_bf16 v[24:27], v[64:67], v[48:51], v[24:27]
    ds_read_b64_tr_b16 v[88:89], v6 offset:4096
    v_mfma_f32_16x16x32_bf16 v[40:43], v[64:67], v[52:55], v[40:43]
    ds_read_b64_tr_b16 v[90:91], v6 offset:6144
    s_waitcnt lgkmcnt(8)
    v_mfma_f32_16x16x32_bf16 v[44:47], v[68:71], v[52:55], v[44:47]
    ds_read_b64_tr_b16 v[92:93], v7 offset:4096
    v_mfma_f32_16x16x32_bf16 v[28:31], v[68:71], v[48:51], v[28:31]
    ds_read_b64_tr_b16 v[94:95], v7 offset:6144
    s_waitcnt vmcnt(0) lgkmcnt(0)
    s_barrier
    s_cmp_lg_u32 s50, 6
    s_cbranch_scc1 L_m_nfl33
    buffer_load_dwordx4 v[124:127], v120, s[32:35], 0 offen sc1
    buffer_load_dwordx4 v[128:131], v120, s[32:35], s9 offen sc1
    buffer_load_dwordx4 v[132:135], v121, s[36:39], 0 offen sc1
L_m_nfl33:
    v_mfma_f32_16x16x32_bf16 v[16:19], v[80:83], v[72:75], v[16:19]
    ds_read_b128 v[48:51], v2 offset:16384
    ds_read_b64_tr_b16 v[56:57], v4 offset:8192
    v_mfma_f32_16x16x32_bf16 v[32:35], v[80:83], v[76:79], v[32:35]
    ds_read_b64_tr_b16 v[58:59], v4 offset:10240
    ds_read_b128 v[52:55], v2 offset:17408
    v_mfma_f32_16x16x32_bf16 v[36:39], v[84:87], v[76:79], v[36:39]
    ds_read_b64_tr_b16 v[60:61], v5 offset:8192
    v_mfma_f32_16x16x32_bf16 v[20:23], v[84:87], v[72:75], v[20:23]
    ds_read_b64_tr_b16 v[62:63], v5 offset:10240
    v_mfma_f32_16x16x32_bf16 v[24:27], v[88:91], v[72:75], v[24:27]
    ds_read_b64_tr_b16 v[64:65], v6 offset:8192
    v_mfma_f32_16x16x32_bf16 v[40:43], v[88:91], v[76:79], v[40:43]
    ds_read_b64_tr_b16 v[66:67], v6 offset:10240
    v_mfma_f32_16x16x32_bf16 v[44:47], v[92:95], v[76:79], v[44:47]
    ds_read_b64_tr_b16 v[68:69], v7 offset:8192
    v_mfma_f32_16x16x32_bf16 v[28:31], v[92:95], v[72:75], v[28:31]
    ds_read_b64_tr_b16 v[70:71], v7 offset:10240
    s_waitcnt lgkmcnt(7)
    v_mfma_f32_16x16x32_bf16 v[16:19], v[56:59], v[48:51], v[16:19]
    ds_read_b128 v[72:75], v2 offset:24576
    ds_read_b64_tr_b16 v[80:81], v4 offset:12288
    s_waitcnt lgkmcnt(8)
    v_mfma_f32_16x16x32_bf16 v[32:35], v[56:59], v[52:55], v[32:35]
    ds_read_b64_tr_b16 v[82:83], v4 offset:14336
    ds_read_b128 v[76:79], v2 offset:25600
    s_waitcnt lgkmcnt(8)
    v_mfma_f32_16x16x32_bf16 v[36:39], v[60:63], v[52:55], v[36:39]
    ds_read_b64_tr_b16 v[84:85], v5 offset:12288
    v_mfma_f32_16x16x32_bf16 v[20:23], v[60:63], v[48:51], v[20:23]
    ds_read_b64_tr_b16 v[86:87], v5 offset:14336
    s_waitcnt lgkmcnt(8)
    v_mfma_f32_16x16x32_bf16 v[24:27], v[64:67], v[48:51], v[24:27]
    ds_read_b64_tr_b16 v[88:89], v6 offset:12288
    v_mfma_f32_16x16x32_bf16 v[40:43], v[64:67], v[52:55], v[40:43]
    ds_read_b64_tr_b16 v[90:91], v6 offset:14336
    s_waitcnt lgkmcnt(8)
    v_mfma_f32_16x16x32_bf16 v[44:47], v[68:71], v[52:55], v[44:47]
    ds_read_b64_tr_b16 v[92:93], v7 offset:12288
    v_mfma_f32_16x16x32_bf16 v[28:31], v[68:71], v[48:51], v[28:31]
    ds_read_b64_tr_b16 v[94:95], v7 offset:14336
    s_waitcnt lgkmcnt(0)
    s_barrier
    v_mfma_f32_16x16x32_bf16 v[16:19], v[80:83], v[72:75], v[16:19]
    ds_read_b128 v[48:51], v2 offset:32768
    ds_read_b64_tr_b16 v[56:57], v4 offset:16384
    v_mfma_f32_16x16x32_bf16 v[32:35], v[80:83], v[76:79], v[32:35]
    ds_read_b64_tr_b16 v[58:59], v4 offset:18432
    ds_read_b128 v[52:55], v2 offset:33792
    v_mfma_f32_16x16x32_bf16 v[36:39], v[84:87], v[76:79], v[36:39]
    ds_read_b64_tr_b16 v[60:61], v5 offset:16384
    v_mfma_f32_16x16x32_bf16 v[20:23], v[84:87], v[72:75], v[20:23]
    ds_read_b64_tr_b16 v[62:63], v5 offset:18432
    v_mfma_f32_16x16x32_bf16 v[24:27], v[88:91], v[72:75], v[24:27]
    ds_read_b64_tr_b16 v[64:65], v6 offset:16384
    v_mfma_f32_16x16x32_bf16 v[40:43], v[88:91], v[76:79], v[40:43]
    ds_read_b64_tr_b16 v[66:67], v6 offset:18432
    v_mfma_f32_16x16x32_bf16 v[44:47], v[92:95], v[76:79], v[44:47]
    ds_read_b64_tr_b16 v[68:69], v7 offset:16384
    v_mfma_f32_16x16x32_bf16 v[28:31], v[92:95], v[72:75], v[28:31]
    ds_read_b64_tr_b16 v[70:71], v7 offset:18432
    s_waitcnt lgkmcnt(7)
    v_mfma_f32_16x16x32_bf16 v[16:19], v[56:59], v[48:51], v[16:19]
    ds_read_b128 v[72:75], v2 offset:40960
    ds_read_b64_tr_b16 v[80:81], v4 offset:20480
    s_waitcnt lgkmcnt(8)
    v_mfma_f32_16x16x32_bf16 v[32:35], v[56:59], v[52:55], v[32:35]
    ds_read_b64_tr_b16 v[82:83], v4 offset:22528
    ds_read_b128 v[76:79], v2 offset:41984
    s_waitcnt lgkmcnt(8)
    v_mfma_f32_16x16x32_bf16 v[36:39], v[60:63], v[52:55], v[36:39]
    ds_read_b64_tr_b16 v[84:85], v5 offset:20480
    v_mfma_f32_16x16x32_bf16 v[20:23], v[60:63], v[48:51], v[20:23]
    ds_read_b64_tr_b16 v[86:87], v5 offset:22528
    s_waitcnt lgkmcnt(8)
    v_mfma_f32_16x16x32_bf16 v[24:27], v[64:67], v[48:51], v[24:27]
    ds_read_b64_tr_b16 v[88:89], v6 offset:20480
    v_mfma_f32_16x16x32_bf16 v[40:43], v[64:67], v[52:55], v[40:43]
    ds_read_b64_tr_b16 v[90:91], v6 offset:22528
    s_waitcnt lgkmcnt(8)
    v_mfma_f32_16x16x32_bf16 v[44:47], v[68:71], v[52:55], v[44:47]
    ds_read_b64_tr_b16 v[92:93], v7 offset:20480
    v_mfma_f32_16x16x32_bf16 v[28:31], v[68:71], v[48:51], v[28:31]
    ds_read_b64_tr_b16 v[94:95], v7 offset:22528
    s_waitcnt lgkmcnt(0)
    s_barrier
    v_mfma_f32_16x16x32_bf16 v[16:19], v[80:83], v[72:75], v[16:19]
    ds_read_b128 v[48:51], v2 offset:49152
    ds_read_b64_tr_b16 v[56:57], v4 offset:24576
    v_mfma_f32_16x16x32_bf16 v[32:35], v[80:83], v[76:79], v[32:35]
    ds_read_b64_tr_b16 v[58:59], v4 offset:26624
    ds_read_b128 v[52:55], v2 offset:50176
    v_mfma_f32_16x16x32_bf16 v[36:39], v[84:87], v[76:79], v[36:39]
    ds_read_b64_tr_b16 v[60:61], v5 offset:24576
    v_mfma_f32_16x16x32_bf16 v[20:23], v[84:87], v[72:75], v[20:23]
    ds_read_b64_tr_b16 v[62:63], v5 offset:26624
    v_mfma_f32_16x16x32_bf16 v[24:27], v[88:91], v[72:75], v[24:27]
    ds_read_b64_tr_b16 v[64:65], v6 offset:24576
    v_mfma_f32_16x16x32_bf16 v[40:43], v[88:91], v[76:79], v[40:43]
    ds_read_b64_tr_b16 v[66:67], v6 offset:26624
    v_mfma_f32_16x16x32_bf16 v[44:47], v[92:95], v[76:79], v[44:47]
    ds_read_b64_tr_b16 v[68:69], v7 offset:24576
    v_mfma_f32_16x16x32_bf16 v[28:31], v[92:95], v[72:75], v[28:31]
    ds_read_b64_tr_b16 v[70:71], v7 offset:26624
    s_waitcnt lgkmcnt(7)
    v_mfma_f32_16x16x32_bf16 v[16:19], v[56:59], v[48:51], v[16:19]
    ds_read_b128 v[72:75], v2 offset:57344
    ds_read_b64_tr_b16 v[80:81], v4 offset:28672
    s_waitcnt lgkmcnt(8)
    v_mfma_f32_16x16x32_bf16 v[32:35], v[56:59], v[52:55], v[32:35]
    ds_read_b64_tr_b16 v[82:83], v4 offset:30720
    ds_read_b128 v[76:79], v2 offset:58368
    s_waitcnt lgkmcnt(8)
    v_mfma_f32_16x16x32_bf16 v[36:39], v[60:63], v[52:55], v[36:39]
    ds_read_b64_tr_b16 v[84:85], v5 offset:28672
    v_mfma_f32_16x16x32_bf16 v[20:23], v[60:63], v[48:51], v[20:23]
    ds_read_b64_tr_b16 v[86:87], v5 offset:30720
    s_waitcnt lgkmcnt(8)
    v_mfma_f32_16x16x32_bf16 v[24:27], v[64:67], v[48:51], v[24:27]
    ds_read_b64_tr_b16 v[88:89], v6 offset:28672
    v_mfma_f32_16x16x32_bf16 v[40:43], v[64:67], v[52:55], v[40:43]
    ds_read_b64_tr_b16 v[90:91], v6 offset:30720
    s_waitcnt lgkmcnt(8)
    v_mfma_f32_16x16x32_bf16 v[44:47], v[68:71], v[52:55], v[44:47]
    ds_read_b64_tr_b16 v[92:93], v7 offset:28672
    v_mfma_f32_16x16x32_bf16 v[28:31], v[68:71], v[48:51], v[28:31]
    ds_read_b64_tr_b16 v[94:95], v7 offset:30720
    s_waitcnt lgkmcnt(0)
    s_barrier
    v_add_u32 v4, s51, v4
    v_add_u32 v5, s51, v5
    v_add_u32 v6, s51, v6
    v_add_u32 v7, s51, v7
    s_sub_u32 s52, s52, 1
    s_cmp_gt_i32 s52, 0
    s_cselect_b32 s51, 32768, 0
    v_mfma_f32_16x16x32_bf16 v[16:19], v[80:83], v[72:75], v[16:19]
    ds_read_b128 v[48:51], v2 offset:0
    ds_read_b64_tr_b16 v[56:57], v4 offset:0
    v_mfma_f32_16x16x32_bf16 v[32:35], v[80:83], v[76:79], v[32:35]
    ds_read_b64_tr_b16 v[58:59], v4 offset:2048
    ds_read_b128 v[52:55], v2 offset:1024
    v_mfma_f32_16x16x32_bf16 v[36:39], v[84:87], v[76:79], v[36:39]
    ds_read_b64_tr_b16 v[60:61], v5 offset:0
    v_mfma_f32_16x16x32_bf16 v[20:23], v[84:87], v[72:75], v[20:23]
    ds_read_b64_tr_b16 v[62:63], v5 offset:2048
    v_mfma_f32_16x16x32_bf16 v[24:27], v[88:91], v[72:75], v[24:27]
    ds_read_b64_tr_b16 v[64:65], v6 offset:0
    v_mfma_f32_16x16x32_bf16 v[40:43], v[88:91], v[76:79], v[40:43]
    ds_read_b64_tr_b16 v[66:67], v6 offset:2048
    v_mfma_f32_16x16x32_bf16 v[44:47], v[92:95], v[76:79], v[44:47]
    ds_read_b64_tr_b16 v[68:69], v7 offset:0
    v_mfma_f32_16x16x32_bf16 v[28:31], v[92:95], v[72:75], v[28:31]
    ds_read_b64_tr_b16 v[70:71], v7 offset:2048
    s_sub_u32 s50, s50, 1
    s_cmp_lg_u32 s50, 0
    s_cbranch_scc1 L_m_cl32
    s_waitcnt lgkmcnt(0)
    s_nop 7
    v_cvt_pk_bf16_f32 v48, v16, v17
    v_cvt_pk_bf16_f32 v49, v18, v19
    v_cvt_pk_bf16_f32 v50, v20, v21
    v_cvt_pk_bf16_f32 v51, v22, v23
    v_cvt_pk_bf16_f32 v52, v24, v25
    v_cvt_pk_bf16_f32 v53, v26, v27
    v_cvt_pk_bf16_f32 v54, v28, v29
    v_cvt_pk_bf16_f32 v55, v30, v31
    v_cvt_pk_bf16_f32 v56, v32, v33
    v_cvt_pk_bf16_f32 v57, v34, v35
    v_cvt_pk_bf16_f32 v58, v36, v37
    v_cvt_pk_bf16_f32 v59, v38, v39
    v_cvt_pk_bf16_f32 v60, v40, v41
    v_cvt_pk_bf16_f32 v61, v42, v43
    v_cvt_pk_bf16_f32 v62, v44, v45
    v_cvt_pk_bf16_f32 v63, v46, v47
    ds_write_b64 v8, v[48:49] offset:0
    ds_write_b64 v8, v[56:57] offset:2048
    v_xor_b32 v9, 32, v8
    ds_write_b64 v9, v[50:51] offset:0
    ds_write_b64 v9, v[58:59] offset:2048
    v_xor_b32 v9, 64, v8
    ds_write_b64 v9, v[52:53] offset:0
    ds_write_b64 v9, v[60:61] offset:2048
    v_xor_b32 v9, 96, v8
    ds_write_b64 v9, v[54:55] offset:0
    ds_write_b64 v9, v[62:63] offset:2048
    s_branch L_m_fin
L_m_prod:
    s_sub_u32 s48, s18, 4
    s_waitcnt lgkmcnt(0)
    v_mov_b32 v2, 274432
    s_add_u32 s44, s94, 9175040
    s_addc_u32 s45, s95, 0
    s_mov_b32 s46, 509952
    s_mov_b32 s47, 0x20000
    buffer_load_dword v2, v2, s[44:47], 0 offen sc1
    s_mov_b32 s20, s72
    s_mov_b32 s21, s73
    s_mov_b32 s22, 4194304
    s_mov_b32 s23, 0x20000
    s_mov_b32 s24, s64
    s_mov_b32 s25, s65
    s_mov_b32 s26, 4194304
    s_mov_b32 s27, 0x20000
    s_mov_b32 s28, s86
    s_mov_b32 s29, s87
    s_mov_b32 s30, 2048
    s_mov_b32 s31, 0x20000
    s_mov_b32 s32, s88
    s_mov_b32 s33, s89
    s_mov_b32 s34, 12582912
    s_mov_b32 s35, 0x20000
    s_add_u32 s36, s94, 8388608
    s_addc_u32 s37, s95, 0
    s_mov_b32 s38, 393216
    s_mov_b32 s39, 0x20000
    s_add_u32 s40, s94, 8912896
    s_addc_u32 s41, s95, 0
    s_mov_b32 s42, 12288
    s_mov_b32 s43, 0x20000
    s_mul_i32 s49, s48, 12928
    s_lshl_b32 s50, s16, 7
    s_lshl_b32 s3, s17, 2
    s_add_u32 s50, s50, s3
    s_add_u32 s50, s50, s48
    s_lshl_b32 s50, s50, 12
    v_lshlrev_b32 v3, 4, v1
    v_add_u32 v6, s49, v3
    v_mov_b32 v88, 0
    v_mov_b32 v89, 0
    v_mov_b32 v90, 0
    v_mov_b32 v91, 0
    s_mov_b32 exec_hi, 0
    ds_write_b128 v6, v[88:91] offset:4096
    s_mov_b64 exec, 3
    ds_write_b128 v6, v[88:91] offset:4608
    s_mov_b64 exec, 1
    ds_write_b128 v6, v[88:91] offset:8768
    v_mov_b32 v7, 151872
    ds_write_b128 v7, v[88:91]
    ds_write_b128 v7, v[88:91] offset:16
    ds_write_b128 v7, v[88:91] offset:32
    v_mov_b32 v7, 98304
    ds_write_b32 v7, v88
    s_mov_b64 exec, -1
    s_lshr_b32 s51, s17, 1
    s_lshl_b32 s52, s16, 1
    s_and_b32 s3, s17, 1
    s_add_u32 s52, s52, s3
    s_lshl_b32 s4, s51, 6
    s_lshl_b32 s3, s48, 4
    s_add_u32 s4, s4, s3
    v_lshrrev_b32 v4, 4, v1
    v_lshlrev_b32 v4, 4, v4
    s_lshl_b32 s3, s51, 7
    v_add_u32 v4, s3, v4
    s_mul_i32 s5, s4, 12288
    s_mul_i32 s3, s52, 768
    s_add_u32 s5, s5, s3
    s_waitcnt lgkmcnt(0)
    s_barrier
    s_and_b32 s3, s2, 14
    s_cmp_eq_u32 s3, 14
    s_cselect_b32 s3, 0, -1
    v_mov_b32 v60, s3
    s_lshl_b32 s3, s2, 10
    s_sub_u32 s3, s3, 1024
    v_lshl_add_u32 v61, v0, 2, s3
    buffer_store_dword v60, v61, s[44:47], 0 offen sc1
    v_mov_b32 v62, -1
    v_mov_b32 v63, -1
    s_mul_i32 s3, s51, 24576
    s_mul_i32 s19, s52, 1536
    s_add_u32 s60, s3, s19
    s_cmp_eq_u32 s48, 3
    s_cbranch_scc1 L_m_ns34
    s_lshl_b32 s3, s48, 9
    v_lshl_add_u32 v5, v1, 3, s3
    buffer_store_dwordx2 v[62:63], v5, s[36:39], s60 offen sc1
    s_branch L_m_ns35
L_m_ns34:
    s_mul_i32 s3, s16, 1536
    s_lshl_b32 s19, s17, 6
    s_add_u32 s3, s3, s19
    s_cmp_ge_u32 s17, 24
    s_cselect_b32 s3, 0x10000, s3
    v_lshlrev_b32 v5, 2, v1
    s_mov_b64 exec, 0xffff
    buffer_store_dword v62, v5, s[40:43], s3 offen sc1
    s_mov_b64 exec, -1
L_m_ns35:
    s_mov_b32 s62, s50
    buffer_load_dwordx4 v[108:111], v4, s[28:31], 0 offen offset:0
    buffer_load_dwordx4 v[112:115], v4, s[28:31], 0 offen offset:64
    s_add_u32 s3, s62, 0
    buffer_load_dwordx4 v[64:67], v3, s[20:23], s3 offen
    buffer_load_dword v68, v3, s[20:23], s3 offen offset:16
    s_add_u32 s3, s62, 1024
    buffer_load_dwordx4 v[70:73], v3, s[20:23], s3 offen
    buffer_load_dword v74, v3, s[20:23], s3 offen offset:16
    s_add_u32 s3, s62, 2048
    buffer_load_dwordx4 v[76:79], v3, s[20:23], s3 offen
    buffer_load_dword v80, v3, s[20:23], s3 offen offset:16
    s_add_u32 s3, s62, 3072
    buffer_load_dwordx4 v[82:85], v3, s[20:23], s3 offen
    buffer_load_dword v86, v3, s[20:23], s3 offen offset:16
    s_waitcnt vmcnt(12)
    v_readfirstlane_b32 s15, v2
    s_nop 0
    s_mul_i32 s15, s15, 0x9E3779B1
    s_add_u32 s15, s15, 0x7F4A7C15
    s_mov_b32 s3, 1366
    v_add_u32 v60, 0, v1
    v_mul_u32_u24 v61, s3, v60
    v_lshrrev_b32 v61, 16, v61
    v_mul_u32_u24 v62, 48, v61
    v_sub_u32 v60, v60, v62
    v_lshlrev_b32 v62, 1, v61
    v_xor_b32 v60, v60, v62
    v_lshlrev_b32 v60, 4, v60
    v_mul_u32_u24 v61, 12288, v61
    v_add_u32 v204, v60, v61
    v_xor_b32 v60, 128, v60
    v_add_u32 v207, v60, v61
    v_add_u32 v60, 64, v1
    v_mul_u32_u24 v61, s3, v60
    v_lshrrev_b32 v61, 16, v61
    v_mul_u32_u24 v62, 48, v61
    v_sub_u32 v60, v60, v62
    v_lshlrev_b32 v62, 1, v61
    v_xor_b32 v60, v60, v62
    v_lshlrev_b32 v60, 4, v60
    v_mul_u32_u24 v61, 12288, v61
    v_add_u32 v205, v60, v61
    v_xor_b32 v60, 128, v60
    v_add_u32 v208, v60, v61
    v_add_u32 v60, 128, v1
    v_mul_u32_u24 v61, s3, v60
    v_lshrrev_b32 v61, 16, v61
    v_mul_u32_u24 v62, 48, v61
    v_sub_u32 v60, v60, v62
    v_lshlrev_b32 v62, 1, v61
    v_xor_b32 v60, v60, v62
    v_lshlrev_b32 v60, 4, v60
    v_mul_u32_u24 v61, 12288, v61
    v_add_u32 v206, v60, v61
    v_xor_b32 v60, 128, v60
    v_add_u32 v209, v60, v61
    v_lshrrev_b32 v60, 4, v1
    v_bfe_u32 v61, v1, 2, 2
    v_lshl_add_u32 v62, v60, 3, v61
    v_mul_u32_u24 v62, 768, v62
    v_and_b32 v63, 3, v1
    v_lshl_add_u32 v62, v63, 3, v62
    v_add_u32 v62, 81920, v62
    v_and_b32 v60, 1, v60
    v_lshl_add_u32 v61, v60, 2, v61
    s_mul_i32 s3, s48, 6
    v_xor_b32 v60, s3, v61
    v_lshl_add_u32 v210, v60, 5, v62
    s_add_u32 s3, s3, 1
    v_xor_b32 v60, s3, v61
    v_lshl_add_u32 v211, v60, 5, v62
    s_add_u32 s3, s3, 1
    v_xor_b32 v60, s3, v61
    v_lshl_add_u32 v212, v60, 5, v62
    s_add_u32 s3, s3, 1
    v_xor_b32 v60, s3, v61
    v_lshl_add_u32 v213, v60, 5, v62
    s_add_u32 s3, s3, 1
    v_xor_b32 v60, s3, v61
    v_lshl_add_u32 v214, v60, 5, v62
    s_add_u32 s3, s3, 1
    v_xor_b32 v60, s3, v61
    v_lshl_add_u32 v215, v60, 5, v62
    s_lshl_b32 s49, s48, 10
    s_lshl_b32 s50, s48, 12
    s_add_u32 s50, s50, 65536
    v_lshrrev_b32 v60, 4, v1
    s_and_b32 s3, s48, 1
    s_lshl_b32 s3, s3, 2
    v_add_u32 v60, s3, v60
    v_and_b32 v61, 7, v1
    v_xor_b32 v60, v60, v61
    v_lshlrev_b32 v60, 4, v60
    v_lshrrev_b32 v61, 3, v1
    s_lshl_b32 s3, s12, 7
    s_lshl_b32 s19, s48, 3
    s_add_u32 s3, s3, s19
    v_add_u32 v61, s3, v61
    v_lshl_add_u32 v8, v61, 11, v60
    v_lshl_add_u32 v12, v61, 12, v60
    v_add_u32 v9, 65536, v8
    v_add_u32 v13, 131072, v12
    v_add_u32 v10, 131072, v8
    v_add_u32 v14, 262144, v12
    v_add_u32 v11, 196608, v8
    v_add_u32 v15, 393216, v12
    v_lshrrev_b32 v60, 4, v1
    v_bfe_u32 v61, v1, 1, 3
    v_xor_b32 v61, v61, v60
    v_lshlrev_b32 v61, 5, v61
    v_and_b32 v62, 1, v1
    v_lshl_add_u32 v61, v62, 4, v61
    s_lshl_b32 s3, s48, 4
    v_add_u32 v60, s3, v60
    v_mul_u32_u24 v60, 7168, v60
    s_lshl_b32 s3, s13, 8
    v_add_u32 v60, s3, v60
    v_add_u32 v16, v61, v60
    v_add_u32 v62, 28672, v60
    v_add_u32 v17, v61, v62
    v_xor_b32 v61, 128, v61
    v_add_u32 v62, 57344, v60
    v_add_u32 v18, v61, v62
    v_add_u32 v62, 86016, v60
    v_add_u32 v19, v61, v62
    s_lshl_b32 s3, s13, 19
    s_lshl_b32 s19, s48, 12
    s_add_u32 s3, s3, s19
    v_lshl_add_u32 v20, v1, 4, s3
    v_add_u32 v21, 1024, v20
    v_add_u32 v22, 2048, v20
    v_add_u32 v23, 3072, v20
    s_lshl_b32 s3, s12, 4
    s_add_u32 s3, s3, s13
    s_lshl_b32 s3, s3, 10
    v_lshl_add_u32 v24, v1, 4, s3
    v_add_u32 v25, 131072, v3
    v_lshrrev_b32 v60, 4, v1
    v_and_b32 v61, 15, v1
    v_lshlrev_b32 v60, 10, v60
    v_lshl_add_u32 v60, v61, 4, v60
    s_lshl_b32 s3, s12, 14
    s_lshl_b32 s19, s48, 8
    s_add_u32 s3, s3, s19
    v_add_u32 v26, s3, v60
    v_lshrrev_b32 v60, 5, v1
    v_lshl_add_u32 v60, v61, 1, v60
    s_add_u32 s3, s19, 133120
    v_lshl_add_u32 v27, v60, 3, s3
    s_lshl_b32 s3, s13, 7
    s_add_u32 s3, s3, 266240
    v_lshl_add_u32 v28, v61, 2, s3
    s_lshl_b32 s19, s12, 2
    s_add_u32 s55, s3, s19
    s_lshl_b32 s3, s12, 12
    s_lshl_b32 s19, s13, 7
    s_add_u32 s56, s3, s19
    s_add_u32 s56, s56, 425984
    s_and_b32 s19, s16, 1
    s_lshl_b32 s19, s19, 11
    s_add_u32 s8, s3, s19
    v_lshlrev_b32 v58, 7, v61
    v_mov_b32 v29, s15
    v_mov_b32 v30, 0
    s_mov_b32 s57, 4096
    s_mov_b32 s58, 8192
    s_mov_b32 s59, 12288
    v_lshrrev_b32 v60, 4, v1
    v_and_b32 v61, 7, v1
    v_xor_b32 v60, v60, v61
    v_and_b32 v61, 56, v1
    v_or_b32 v60, v60, v61
    v_lshlrev_b32 v50, 4, v60
    v_xor_b32 v51, 64, v50
    s_mul_i32 s3, s12, 458752
    s_lshl_b32 s19, s48, 12
    s_add_u32 s3, s3, s19
    v_lshl_add_u32 v52, v1, 4, s3
    v_add_u32 v53, 1024, v52
    v_add_u32 v54, 2048, v52
    v_add_u32 v55, 3072, v52
    v_lshrrev_b32 v60, 4, v1
    v_lshlrev_b32 v60, 1, v60
    v_and_b32 v61, 7, v1
    v_xor_b32 v60, v60, v61
    v_lshlrev_b32 v60, 4, v60
    v_lshrrev_b32 v61, 3, v1
    v_lshl_add_u32 v60, v61, 11, v60
    v_and_b32 v60, 0x70, v60
    v_lshl_add_u32 v60, v61, 7, v60
    s_lshl_b32 s3, s48, 11
    s_mul_i32 s19, s14, 229376
    s_add_u32 s3, s3, s19
    v_add_u32 v56, s3, v60
    v_add_u32 v57, 1024, v56
    s_barrier
    s_waitcnt vmcnt(10)
    s_barrier
    s_waitcnt vmcnt(6)
    ds_write_b128 v6, v[64:67] offset:4640
    v_alignbit_b32 v92, v65, v64, 16
    v_alignbit_b32 v93, v66, v65, 16
    v_alignbit_b32 v94, v67, v66, 16
    v_alignbit_b32 v95, v68, v67, 16
    ds_write_b128 v6, v[92:95] offset:8800
    v_lshlrev_b32 v91, 16, v64
    s_mov_b64 exec, 1
    ds_write_b128 v6, v[88:91] offset:8784
    s_mov_b64 exec, -1
    s_waitcnt vmcnt(4)
    ds_write_b128 v6, v[70:73] offset:5664
    v_alignbit_b32 v96, v71, v70, 16
    v_alignbit_b32 v97, v72, v71, 16
    v_alignbit_b32 v98, v73, v72, 16
    v_alignbit_b32 v99, v74, v73, 16
    ds_write_b128 v6, v[96:99] offset:9824
    s_waitcnt vmcnt(2)
    ds_write_b128 v6, v[76:79] offset:6688
    v_alignbit_b32 v100, v77, v76, 16
    v_alignbit_b32 v101, v78, v77, 16
    v_alignbit_b32 v102, v79, v78, 16
    v_alignbit_b32 v103, v80, v79, 16
    ds_write_b128 v6, v[100:103] offset:10848
    s_waitcnt vmcnt(0)
    ds_write_b128 v6, v[82:85] offset:7712
    v_alignbit_b32 v104, v83, v82, 16
    v_alignbit_b32 v105, v84, v83, 16
    v_alignbit_b32 v106, v85, v84, 16
    v_alignbit_b32 v107, v86, v85, 16
    ds_write_b128 v6, v[104:107] offset:11872
    s_waitcnt lgkmcnt(0)
    v_mov_b32 v62, 151896
    v_mov_b32 v63, 1
    s_mov_b64 exec, 1
    ds_add_u32 v62, v63
    s_mov_b64 exec, -1
    s_waitcnt vmcnt(8)
    v_lshlrev_b32 v116, 16, v108
    v_and_b32 v117, 0xffff0000, v108
    v_lshlrev_b32 v118, 16, v109
    v_and_b32 v119, 0xffff0000, v109
    v_lshlrev_b32 v120, 16, v110
    v_and_b32 v121, 0xffff0000, v110
    v_lshlrev_b32 v122, 16, v111
    v_and_b32 v123, 0xffff0000, v111
    v_lshlrev_b32 v124, 16, v112
    v_and_b32 v125, 0xffff0000, v112
    v_lshlrev_b32 v126, 16, v113
    v_and_b32 v127, 0xffff0000, v113
    v_lshlrev_b32 v128, 16, v114
    v_and_b32 v129, 0xffff0000, v114
    v_lshlrev_b32 v130, 16, v115
    v_and_b32 v131, 0xffff0000, v115
    s_mov_b32 s4, 0xbfb8aa3b
    v_mul_f32 v132, s4, v116
    v_mul_f32 v133, s4, v117
    v_mul_f32 v134, s4, v118
    v_mul_f32 v135, s4, v119
    v_mul_f32 v136, s4, v120
    v_mul_f32 v137, s4, v121
    v_mul_f32 v138, s4, v122
    v_mul_f32 v139, s4, v123
    v_mul_f32 v140, s4, v124
    v_mul_f32 v141, s4, v125
    v_mul_f32 v142, s4, v126
    v_mul_f32 v143, s4, v127
    v_mul_f32 v144, s4, v128
    v_mul_f32 v145, s4, v129
    v_mul_f32 v146, s4, v130
    v_mul_f32 v147, s4, v131
    v_exp_f32 v132, v132
    v_exp_f32 v133, v133
    v_exp_f32 v134, v134
    v_exp_f32 v135, v135
    v_exp_f32 v136, v136
    v_exp_f32 v137, v137
    v_exp_f32 v138, v138
    v_exp_f32 v139, v139
    v_exp_f32 v140, v140
    v_exp_f32 v141, v141
    v_exp_f32 v142, v142
    v_exp_f32 v143, v143
    v_exp_f32 v144, v144
    v_exp_f32 v145, v145
    v_exp_f32 v146, v146
    v_exp_f32 v147, v147
    v_add_f32 v132, 1.0, v132
    v_add_f32 v133, 1.0, v133
    v_add_f32 v134, 1.0, v134
    v_add_f32 v135, 1.0, v135
    v_add_f32 v136, 1.0, v136
    v_add_f32 v137, 1.0, v137
    v_add_f32 v138, 1.0, v138
    v_add_f32 v139, 1.0, v139
    v_add_f32 v140, 1.0, v140
    v_add_f32 v141, 1.0, v141
    v_add_f32 v142, 1.0, v142
    v_add_f32 v143, 1.0, v143
    v_add_f32 v144, 1.0, v144
    v_add_f32 v145, 1.0, v145
    v_add_f32 v146, 1.0, v146
    v_add_f32 v147, 1.0, v147
    v_rcp_f32 v132, v132
    v_rcp_f32 v133, v133
    v_rcp_f32 v134, v134
    v_rcp_f32 v135, v135
    v_rcp_f32 v136, v136
    v_rcp_f32 v137, v137
    v_rcp_f32 v138, v138
    v_rcp_f32 v139, v139
    v_rcp_f32 v140, v140
    v_rcp_f32 v141, v141
    v_rcp_f32 v142, v142
    v_rcp_f32 v143, v143
    v_rcp_f32 v144, v144
    v_rcp_f32 v145, v145
    v_rcp_f32 v146, v146
    v_rcp_f32 v147, v147
    v_mul_f32 v116, v116, v132
    v_mul_f32 v117, v117, v133
    v_mul_f32 v118, v118, v134
    v_mul_f32 v119, v119, v135
    v_mul_f32 v120, v120, v136
    v_mul_f32 v121, v121, v137
    v_mul_f32 v122, v122, v138
    v_mul_f32 v123, v123, v139
    v_mul_f32 v124, v124, v140
    v_mul_f32 v125, v125, v141
    v_mul_f32 v126, v126, v142
    v_mul_f32 v127, v127, v143
    v_mul_f32 v128, v128, v144
    v_mul_f32 v129, v129, v145
    v_mul_f32 v130, v130, v146
    v_mul_f32 v131, v131, v147
    v_cvt_pk_bf16_f32 v148, v116, v117
    v_cvt_pk_bf16_f32 v149, v118, v119
    v_cvt_pk_bf16_f32 v150, v120, v121
    v_cvt_pk_bf16_f32 v151, v122, v123
    v_cvt_pk_bf16_f32 v152, v124, v125
    v_cvt_pk_bf16_f32 v153, v126, v127
    v_cvt_pk_bf16_f32 v154, v128, v129
    v_cvt_pk_bf16_f32 v155, v130, v131
    v_and_b32 v60, 15, v1
    v_cmp_eq_u32 vcc, 0, v60
    s_nop 1
    v_cndmask_b32 v156, 0, v148, vcc
    v_cndmask_b32 v157, 0, v149, vcc
    v_cndmask_b32 v158, 0, v150, vcc
    v_cndmask_b32 v159, 0, v151, vcc
    v_cndmask_b32 v160, 0, v152, vcc
    v_cndmask_b32 v161, 0, v153, vcc
    v_cndmask_b32 v162, 0, v154, vcc
    v_cndmask_b32 v163, 0, v155, vcc
    v_cmp_eq_u32 vcc, 4, v60
    s_nop 1
    v_cndmask_b32 v164, 0, v148, vcc
    v_cndmask_b32 v165, 0, v149, vcc
    v_cndmask_b32 v166, 0, v150, vcc
    v_cndmask_b32 v167, 0, v151, vcc
    v_cndmask_b32 v168, 0, v152, vcc
    v_cndmask_b32 v169, 0, v153, vcc
    v_cndmask_b32 v170, 0, v154, vcc
    v_cndmask_b32 v171, 0, v155, vcc
    v_cmp_eq_u32 vcc, 8, v60
    s_nop 1
    v_cndmask_b32 v172, 0, v148, vcc
    v_cndmask_b32 v173, 0, v149, vcc
    v_cndmask_b32 v174, 0, v150, vcc
    v_cndmask_b32 v175, 0, v151, vcc
    v_cndmask_b32 v176, 0, v152, vcc
    v_cndmask_b32 v177, 0, v153, vcc
    v_cndmask_b32 v178, 0, v154, vcc
    v_cndmask_b32 v179, 0, v155, vcc
    v_cmp_eq_u32 vcc, 12, v60
    s_nop 1
    v_cndmask_b32 v180, 0, v148, vcc
    v_cndmask_b32 v181, 0, v149, vcc
    v_cndmask_b32 v182, 0, v150, vcc
    v_cndmask_b32 v183, 0, v151, vcc
    v_cndmask_b32 v184, 0, v152, vcc
    v_cndmask_b32 v185, 0, v153, vcc
    v_cndmask_b32 v186, 0, v154, vcc
    v_cndmask_b32 v187, 0, v155, vcc
    v_cmp_eq_u32 vcc, 1, v60
    s_nop 1
    v_cndmask_b32 v188, 0, v148, vcc
    v_cndmask_b32 v189, 0, v149, vcc
    v_cndmask_b32 v190, 0, v150, vcc
    v_cndmask_b32 v191, 0, v151, vcc
    v_cndmask_b32 v192, 0, v152, vcc
    v_cndmask_b32 v193, 0, v153, vcc
    v_cndmask_b32 v194, 0, v154, vcc
    v_cndmask_b32 v195, 0, v155, vcc
    v_cmp_eq_u32 vcc, 5, v60
    s_nop 1
    v_cndmask_b32 v196, 0, v148, vcc
    v_cndmask_b32 v197, 0, v149, vcc
    v_cndmask_b32 v198, 0, v150, vcc
    v_cndmask_b32 v199, 0, v151, vcc
    v_cndmask_b32 v200, 0, v152, vcc
    v_cndmask_b32 v201, 0, v153, vcc
    v_cndmask_b32 v202, 0, v154, vcc
    v_cndmask_b32 v203, 0, v155, vcc
    v_mov_b32 v62, 151900
    s_mov_b32 s11, 0
L_m_lw36:
    ds_read_b32 v63, v62
    s_add_u32 s11, s11, 1
    s_cmp_gt_u32 s11, 2097152
    s_cbranch_scc1 L_m_lo37
    s_waitcnt lgkmcnt(0)
    v_readfirstlane_b32 s10, v63
    s_nop 0
    s_cmp_ge_u32 s10, 4
    s_cbranch_scc1 L_m_lo37
    s_sleep 2
    s_branch L_m_lw36
L_m_lo37:
    s_mul_i32 s4, s48, 12288
    s_add_u32 s4, s4, 81920
    s_add_u32 m0, s4, 0
    s_nop 0
    buffer_load_dwordx4 v204, s[32:35], s5 offen  lds
    s_waitcnt vmcnt(3)
    s_add_u32 m0, s4, 1024
    s_nop 0
    buffer_load_dwordx4 v205, s[32:35], s5 offen  lds
    s_waitcnt vmcnt(3)
    s_add_u32 m0, s4, 2048
    s_nop 0
    buffer_load_dwordx4 v206, s[32:35], s5 offen  lds
    s_waitcnt vmcnt(3)
    s_add_u32 m0, s4, 3072
    s_add_u32 s5, s5, 49152
    buffer_load_dwordx4 v204, s[32:35], s5 offen  lds
    s_waitcnt vmcnt(3)
    s_add_u32 m0, s4, 4096
    s_nop 0
    buffer_load_dwordx4 v205, s[32:35], s5 offen  lds
    s_waitcnt vmcnt(3)
    s_add_u32 m0, s4, 5120
    s_nop 0
    buffer_load_dwordx4 v206, s[32:35], s5 offen  lds
    s_waitcnt vmcnt(3)
    s_add_u32 m0, s4, 6144
    s_add_u32 s5, s5, 49152
    buffer_load_dwordx4 v207, s[32:35], s5 offen  lds
    s_waitcnt vmcnt(3)
    s_add_u32 m0, s4, 7168
    s_nop 0
    buffer_load_dwordx4 v208, s[32:35], s5 offen  lds
    s_waitcnt vmcnt(3)
    s_add_u32 m0, s4, 8192
    s_nop 0
    buffer_load_dwordx4 v209, s[32:35], s5 offen  lds
    s_waitcnt vmcnt(3)
    s_add_u32 m0, s4, 9216
    s_add_u32 s5, s5, 49152
    buffer_load_dwordx4 v207, s[32:35], s5 offen  lds
    s_waitcnt vmcnt(3)
    s_add_u32 m0, s4, 10240
    s_nop 0
    buffer_load_dwordx4 v208, s[32:35], s5 offen  lds
    s_waitcnt vmcnt(3)
    s_add_u32 m0, s4, 11264
    s_nop 0
    buffer_load_dwordx4 v209, s[32:35], s5 offen  lds
    s_waitcnt vmcnt(3)
    s_waitcnt vmcnt(0)
    s_setprio 3
    s_lshl_b32 s6, s97, 14
    s_lshl_b32 s3, s48, 12
    s_add_u32 s6, s6, s3
    s_mul_i32 s7, s48, 4160
    s_add_u32 s7, s7, 135168
    s_add_u32 m0, s7, 0
    s_add_u32 s3, s6, 0
    buffer_load_dwordx4 v3, s[24:27], s3 offen  lds
    s_add_u32 m0, s7, 1024
    s_add_u32 s3, s6, 1024
    buffer_load_dwordx4 v3, s[24:27], s3 offen  lds
    s_add_u32 m0, s7, 2080
    s_add_u32 s3, s6, 2048
    buffer_load_dwordx4 v3, s[24:27], s3 offen  lds
    s_add_u32 m0, s7, 3104
    s_add_u32 s3, s6, 3072
    buffer_load_dwordx4 v3, s[24:27], s3 offen  lds
    s_mov_b32 s20, s78
    s_mov_b32 s21, s79
    s_mov_b32 s22, 7340032
    s_mov_b32 s23, 0x20000
    s_lshl_b32 s3, s2, 2
    s_add_u32 s3, s3, s48
    s_mul_i32 s3, s3, 7168
    s_add_u32 s3, s3, 3584
    v_lshlrev_b32 v60, 7, v1
    s_mov_b32 exec_lo, 0xfffffff
    s_mov_b32 exec_hi, 0
    buffer_load_dword v216, v60, s[20:23], s3 offen
    s_mov_b64 exec, -1
    v_mov_b32 v62, 151872
    v_mov_b32 v63, 1
    s_waitcnt lgkmcnt(0)
    s_mov_b64 s[10:11], exec
    s_mov_b64 exec, 1
    ds_add_u32 v62, v63
    s_mov_b64 exec, s[10:11]
    s_mov_b32 s11, 0
L_m_ls38:
    ds_read_b32 v63, v62
    s_add_u32 s11, s11, 1
    s_cmp_gt_u32 s11, 1048576
    s_cbranch_scc1 L_m_lk39
    s_waitcnt lgkmcnt(0)
    v_readfirstlane_b32 s10, v63
    s_sleep 2
    s_cmp_lt_u32 s10, 4
    s_cbranch_scc1 L_m_ls38
L_m_lk39:
    ds_read_b64_tr_b16 v[64:65], v210 offset:0
    ds_read_b64_tr_b16 v[66:67], v210 offset:3072
    ds_read_b64_tr_b16 v[68:69], v210 offset:24576
    ds_read_b64_tr_b16 v[70:71], v210 offset:27648
    ds_read_b64_tr_b16 v[72:73], v211 offset:0
    ds_read_b64_tr_b16 v[74:75], v211 offset:3072
    ds_read_b64_tr_b16 v[76:77], v211 offset:24576
    ds_read_b64_tr_b16 v[78:79], v211 offset:27648
    ds_read_b64_tr_b16 v[80:81], v212 offset:0
    ds_read_b64_tr_b16 v[82:83], v212 offset:3072
    ds_read_b64_tr_b16 v[84:85], v212 offset:24576
    ds_read_b64_tr_b16 v[86:87], v212 offset:27648
    ds_read_b64_tr_b16 v[88:89], v213 offset:0
    ds_read_b64_tr_b16 v[90:91], v213 offset:3072
    ds_read_b64_tr_b16 v[92:93], v213 offset:24576
    ds_read_b64_tr_b16 v[94:95], v213 offset:27648
    ds_read_b64_tr_b16 v[96:97], v214 offset:0
    ds_read_b64_tr_b16 v[98:99], v214 offset:3072
    ds_read_b64_tr_b16 v[100:101], v214 offset:24576
    ds_read_b64_tr_b16 v[102:103], v214 offset:27648
    ds_read_b64_tr_b16 v[104:105], v215 offset:0
    ds_read_b64_tr_b16 v[106:107], v215 offset:3072
    ds_read_b64_tr_b16 v[108:109], v215 offset:24576
    ds_read_b64_tr_b16 v[110:111], v215 offset:27648
    s_mul_i32 s3, s48, 384
    s_add_u32 s3, s3, s60
    v_lshlrev_b32 v60, 2, v1
    s_waitcnt lgkmcnt(15)
    v_mfma_f32_16x16x32_bf16 v[112:115], v[156:159], v[64:67], 0
    v_mfma_f32_16x16x32_bf16 v[112:115], v[160:163], v[68:71], v[112:115]
    s_waitcnt lgkmcnt(15)
    v_mfma_f32_16x16x32_bf16 v[112:115], v[164:167], v[72:75], v[112:115]
    v_mfma_f32_16x16x32_bf16 v[112:115], v[168:171], v[76:79], v[112:115]
    s_waitcnt lgkmcnt(12)
    v_mfma_f32_16x16x32_bf16 v[112:115], v[172:175], v[80:83], v[112:115]
    v_mfma_f32_16x16x32_bf16 v[112:115], v[176:179], v[84:87], v[112:115]
    s_waitcnt lgkmcnt(8)
    v_mfma_f32_16x16x32_bf16 v[112:115], v[180:183], v[88:91], v[112:115]
    v_mfma_f32_16x16x32_bf16 v[112:115], v[184:187], v[92:95], v[112:115]
    s_waitcnt lgkmcnt(4)
    v_mfma_f32_16x16x32_bf16 v[112:115], v[188:191], v[96:99], v[112:115]
    v_mfma_f32_16x16x32_bf16 v[112:115], v[192:195], v[100:103], v[112:115]
    s_waitcnt lgkmcnt(0)
    v_mfma_f32_16x16x32_bf16 v[112:115], v[196:199], v[104:107], v[112:115]
    v_mfma_f32_16x16x32_bf16 v[112:115], v[200:203], v[108:111], v[112:115]
    s_nop 7
    buffer_store_dword v112, v60, s[36:39], s3 offen sc1
    s_mov_b32 exec_hi, 0
    buffer_store_dword v113, v60, s[36:39], s3 offen offset:256 sc1
    s_mov_b64 exec, -1
    s_cmp_lg_u32 s48, 3
    s_cbranch_scc1 L_m_pb5
    s_cmp_ge_u32 s17, 24
    s_cbranch_scc1 L_m_pb5
    v_lshlrev_b32 v60, 2, v1
    s_mul_i32 s4, s16, 768
    s_lshl_b32 s3, s17, 5
    s_add_u32 s4, s4, s3
    s_lshr_b32 s3, s4, 10
    s_cmp_eq_u32 s3, 1
    s_cselect_b32 s61, 1.0, 0
    s_cmp_eq_u32 s3, 4
    s_cselect_b32 s61, 1.0, s61
    s_lshl_b32 s5, s4, 2
    s_lshl_b32 s4, s4, 1
    v_lshlrev_b32 v63, 3, v1
    s_mov_b64 exec, 0xffff
    s_mov_b32 s11, 0
L_m_gl40:
    s_mov_b32 s6, s5
    buffer_load_dwordx2 v[64:65], v63, s[36:39], s6 offen sc1
    s_add_u32 s6, s6, 24576
    buffer_load_dwordx2 v[66:67], v63, s[36:39], s6 offen sc1
    s_add_u32 s6, s6, 24576
    buffer_load_dwordx2 v[68:69], v63, s[36:39], s6 offen sc1
    s_add_u32 s6, s6, 24576
    buffer_load_dwordx2 v[70:71], v63, s[36:39], s6 offen sc1
    s_add_u32 s6, s6, 24576
    buffer_load_dwordx2 v[72:73], v63, s[36:39], s6 offen sc1
    s_add_u32 s6, s6, 24576
    buffer_load_dwordx2 v[74:75], v63, s[36:39], s6 offen sc1
    s_add_u32 s6, s6, 24576
    buffer_load_dwordx2 v[76:77], v63, s[36:39], s6 offen sc1
    s_add_u32 s6, s6, 24576
    buffer_load_dwordx2 v[78:79], v63, s[36:39], s6 offen sc1
    s_add_u32 s6, s6, 24576
    buffer_load_dwordx2 v[80:81], v63, s[36:39], s6 offen sc1
    s_add_u32 s6, s6, 24576
    buffer_load_dwordx2 v[82:83], v63, s[36:39], s6 offen sc1
    s_add_u32 s6, s6, 24576
    buffer_load_dwordx2 v[84:85], v63, s[36:39], s6 offen sc1
    s_add_u32 s6, s6, 24576
    buffer_load_dwordx2 v[86:87], v63, s[36:39], s6 offen sc1
    s_add_u32 s6, s6, 24576
    buffer_load_dwordx2 v[88:89], v63, s[36:39], s6 offen sc1
    s_add_u32 s6, s6, 24576
    buffer_load_dwordx2 v[90:91], v63, s[36:39], s6 offen sc1
    s_add_u32 s6, s6, 24576
    buffer_load_dwordx2 v[92:93], v63, s[36:39], s6 offen sc1
    s_add_u32 s6, s6, 24576
    buffer_load_dwordx2 v[94:95], v63, s[36:39], s6 offen sc1
    s_add_u32 s11, s11, 1
    s_cmp_gt_u32 s11, 131072
    s_cbranch_scc1 L_m_go41
    s_waitcnt vmcnt(0)
    v_max3_u32 v61, v64, v66, v68
    v_max3_u32 v61, v61, v70, v72
    v_max3_u32 v61, v61, v74, v76
    v_max3_u32 v61, v61, v78, v80
    v_max3_u32 v61, v61, v82, v84
    v_max3_u32 v61, v61, v86, v88
    v_max3_u32 v61, v61, v90, v92
    v_max_u32 v61, v61, v94
    v_cmp_eq_u32 vcc, -1, v61
    s_sleep 2
    s_cbranch_vccnz L_m_gl40
L_m_go41:
    v_pk_add_f32 v[64:65], v[64:65], v[80:81]
    v_pk_add_f32 v[66:67], v[66:67], v[82:83]
    v_pk_add_f32 v[68:69], v[68:69], v[84:85]
    v_pk_add_f32 v[70:71], v[70:71], v[86:87]
    v_pk_add_f32 v[72:73], v[72:73], v[88:89]
    v_pk_add_f32 v[74:75], v[74:75], v[90:91]
    v_pk_add_f32 v[76:77], v[76:77], v[92:93]
    v_pk_add_f32 v[78:79], v[78:79], v[94:95]
    v_pk_add_f32 v[64:65], v[64:65], v[72:73]
    v_pk_add_f32 v[66:67], v[66:67], v[74:75]
    v_pk_add_f32 v[68:69], v[68:69], v[76:77]
    v_pk_add_f32 v[70:71], v[70:71], v[78:79]
    v_pk_add_f32 v[64:65], v[64:65], v[68:69]
    v_pk_add_f32 v[66:67], v[66:67], v[70:71]
    v_pk_add_f32 v[64:65], v[64:65], v[66:67]
    v_cvt_pk_bf16_f32 v66, v64, v65
    v_lshlrev_b32 v64, 16, v66
    v_and_b32 v65, 0xffff0000, v66
    v_add_f32 v64, s61, v64
    v_add_f32 v65, s61, v65
    v_cvt_pk_bf16_f32 v64, v64, v65
    buffer_store_dword v64, v60, s[40:43], s4 offen sc1
    s_mov_b64 exec, -1
L_m_pb5:
    s_setprio 0
    s_waitcnt vmcnt(3)
    v_add_u32 v7, s7, v3
    ds_read_b128 v[144:147], v7 offset:0
    ds_read_b128 v[148:151], v7 offset:1024
    ds_read_b128 v[152:155], v7 offset:2080
    ds_read_b128 v[156:159], v7 offset:3104
    s_waitcnt lgkmcnt(0)
    v_lshlrev_b32 v160, 16, v144
    v_and_b32 v161, 0xffff0000, v144
    v_lshlrev_b32 v162, 16, v145
    v_and_b32 v163, 0xffff0000, v145
    v_lshlrev_b32 v164, 16, v146
    v_and_b32 v165, 0xffff0000, v146
    v_lshlrev_b32 v166, 16, v147
    v_and_b32 v167, 0xffff0000, v147
    v_lshlrev_b32 v168, 16, v148
    v_and_b32 v169, 0xffff0000, v148
    v_lshlrev_b32 v170, 16, v149
    v_and_b32 v171, 0xffff0000, v149
    v_lshlrev_b32 v172, 16, v150
    v_and_b32 v173, 0xffff0000, v150
    v_lshlrev_b32 v174, 16, v151
    v_and_b32 v175, 0xffff0000, v151
    v_pk_add_f32 v[192:193], v[160:161], v[162:163]
    v_pk_mul_f32 v[194:195], v[160:161], v[160:161]
    v_pk_fma_f32 v[194:195], v[162:163], v[162:163], v[194:195]
    v_pk_fma_f32 v[194:195], v[164:165], v[164:165], v[194:195]
    v_pk_fma_f32 v[194:195], v[166:167], v[166:167], v[194:195]
    v_pk_fma_f32 v[194:195], v[168:169], v[168:169], v[194:195]
    v_pk_fma_f32 v[194:195], v[170:171], v[170:171], v[194:195]
    v_pk_fma_f32 v[194:195], v[172:173], v[172:173], v[194:195]
    v_pk_fma_f32 v[194:195], v[174:175], v[174:175], v[194:195]
    v_pk_add_f32 v[192:193], v[192:193], v[164:165]
    v_pk_add_f32 v[192:193], v[192:193], v[166:167]
    v_pk_add_f32 v[192:193], v[192:193], v[168:169]
    v_pk_add_f32 v[192:193], v[192:193], v[170:171]
    v_pk_add_f32 v[192:193], v[192:193], v[172:173]
    v_pk_add_f32 v[192:193], v[192:193], v[174:175]
    v_add_f32 v196, v192, v193
    v_add_f32 v198, v194, v195
    v_lshlrev_b32 v176, 16, v152
    v_and_b32 v177, 0xffff0000, v152
    v_lshlrev_b32 v178, 16, v153
    v_and_b32 v179, 0xffff0000, v153
    v_lshlrev_b32 v180, 16, v154
    v_and_b32 v181, 0xffff0000, v154
    v_lshlrev_b32 v182, 16, v155
    v_and_b32 v183, 0xffff0000, v155
    v_lshlrev_b32 v184, 16, v156
    v_and_b32 v185, 0xffff0000, v156
    v_lshlrev_b32 v186, 16, v157
    v_and_b32 v187, 0xffff0000, v157
    v_lshlrev_b32 v188, 16, v158
    v_and_b32 v189, 0xffff0000, v158
    v_lshlrev_b32 v190, 16, v159
    v_and_b32 v191, 0xffff0000, v159
    v_pk_add_f32 v[192:193], v[176:177], v[178:179]
    v_pk_mul_f32 v[194:195], v[176:177], v[176:177]
    v_pk_fma_f32 v[194:195], v[178:179], v[178:179], v[194:195]
    v_pk_fma_f32 v[194:195], v[180:181], v[180:181], v[194:195]
    v_pk_fma_f32 v[194:195], v[182:183], v[182:183], v[194:195]
    v_pk_fma_f32 v[194:195], v[184:185], v[184:185], v[194:195]
    v_pk_fma_f32 v[194:195], v[186:187], v[186:187], v[194:195]
    v_pk_fma_f32 v[194:195], v[188:189], v[188:189], v[194:195]
    v_pk_fma_f32 v[194:195], v[190:191], v[190:191], v[194:195]
    v_pk_add_f32 v[192:193], v[192:193], v[180:181]
    v_pk_add_f32 v[192:193], v[192:193], v[182:183]
    v_pk_add_f32 v[192:193], v[192:193], v[184:185]
    v_pk_add_f32 v[192:193], v[192:193], v[186:187]
    v_pk_add_f32 v[192:193], v[192:193], v[188:189]
    v_pk_add_f32 v[192:193], v[192:193], v[190:191]
    v_add_f32 v197, v192, v193
    v_add_f32 v199, v194, v195
    s_nop 1
    v_permlane32_swap_b32 v196, v197
    v_permlane32_swap_b32 v198, v199
    v_add_f32 v196, v196, v197
    v_add_f32 v198, v198, v199
    v_mov_b32 v197, v196
    v_mov_b32 v199, v198
    s_nop 1
    v_permlane16_swap_b32 v197, v196
    v_permlane16_swap_b32 v199, v198
    v_add_f32 v196, v196, v197
    v_add_f32 v198, v198, v199
    s_nop 0
    v_add_f32_dpp v196, v196, v196 row_ror:8 row_mask:0xf bank_mask:0xf
    v_add_f32_dpp v198, v198, v198 row_ror:8 row_mask:0xf bank_mask:0xf
    s_nop 0
    v_add_f32_dpp v196, v196, v196 row_ror:4 row_mask:0xf bank_mask:0xf
    v_add_f32_dpp v198, v198, v198 row_ror:4 row_mask:0xf bank_mask:0xf
    s_nop 0
    v_add_f32_dpp v196, v196, v196 quad_perm:[1,0,3,2] row_mask:0xf bank_mask:0xf
    v_add_f32_dpp v198, v198, v198 quad_perm:[1,0,3,2] row_mask:0xf bank_mask:0xf
    s_nop 0
    v_add_f32_dpp v196, v196, v196 quad_perm:[2,3,0,1] row_mask:0xf bank_mask:0xf
    v_add_f32_dpp v198, v198, v198 quad_perm:[2,3,0,1] row_mask:0xf bank_mask:0xf
    s_mov_b32 s10, 0x3a800000
    v_mul_f32 v196, s10, v196
    v_mul_f32 v197, v196, v196
    v_fma_f32 v198, v198, s10, -v197
    v_max_f32 v198, 0, v198
    v_add_f32 v198, 0x3727c5ac, v198
    v_rsq_f32 v192, v198
    s_nop 0
    v_mul_f32_e64 v193, -v196, v192
    v_lshrrev_b32 v7, 5, v1
    v_lshlrev_b32 v7, 3, v7
    s_lshl_b32 s3, s48, 4
    s_add_u32 s3, s3, 151808
    v_add_u32 v7, s3, v7
    ds_write_b64 v7, v[192:193]
    s_waitcnt lgkmcnt(0)
    v_mov_b32 v62, 151876
    v_mov_b32 v63, 1
    s_mov_b64 exec, 1
    ds_add_u32 v62, v63
    s_mov_b64 exec, -1
    s_setprio 0
    s_add_u32 s20, s94, 12582912
    s_addc_u32 s21, s95, 0
    s_mov_b32 s22, 4194304
    s_mov_b32 s23, 0x20000
    s_mov_b32 s24, s78
    s_mov_b32 s25, s79
    s_mov_b32 s26, 7340032
    s_mov_b32 s27, 0x20000
    s_mov_b32 s28, s80
    s_mov_b32 s29, s81
    s_mov_b32 s30, 8388608
    s_mov_b32 s31, 0x20000
    s_mov_b32 s32, s94
    s_mov_b32 s33, s95
    s_mov_b32 s34, 7340032
    s_mov_b32 s35, 0x20000
    s_add_u32 s36, s94, 12582912
    s_addc_u32 s37, s95, 0
    s_mov_b32 s38, 4194304
    s_mov_b32 s39, 0x20000
    s_lshl_b32 s4, s48, 12
    s_lshl_b32 s5, s97, 14
    s_add_u32 s5, s5, s4
    s_mov_b32 s53, 0
    s_mov_b32 s54, 3584
    s_mov_b32 s6, 458752
    s_mov_b32 s9, 128
    s_barrier
    s_add_u32 m0, s4, 0
    s_add_u32 s3, s5, 0
    buffer_load_dwordx4 v50, s[36:39], s3 offen sc1 lds
    s_add_u32 m0, s4, 1024
    s_add_u32 s3, s5, 1024
    buffer_load_dwordx4 v51, s[36:39], s3 offen sc1 lds
    s_add_u32 m0, s4, 2048
    s_add_u32 s3, s5, 2048
    buffer_load_dwordx4 v50, s[36:39], s3 offen sc1 lds
    s_add_u32 m0, s4, 3072
    s_add_u32 s3, s5, 3072
    buffer_load_dwordx4 v51, s[36:39], s3 offen sc1 lds
    v_mov_b32 v62, 98304
    ds_write_b32 v62, v30
    s_waitcnt vmcnt(0) lgkmcnt(0)
    s_barrier
    s_barrier
    s_barrier
    s_cmp_ge_u32 s17, 28
    s_cbranch_scc1 L_m_pspare
    s_add_u32 m0, s50, 0
    s_nop 0
    buffer_load_dwordx4 v16, s[24:27], s54 offen sc1 lds
    s_add_u32 m0, s50, 1024
    s_nop 0
    buffer_load_dwordx4 v17, s[24:27], s54 offen sc1 lds
    s_add_u32 m0, s50, 2048
    s_nop 0
    buffer_load_dwordx4 v18, s[24:27], s54 offen sc1 lds
    s_add_u32 m0, s50, 3072
    s_nop 0
    buffer_load_dwordx4 v19, s[24:27], s54 offen sc1 lds
    s_add_u32 s54, s54, s6
    s_add_u32 m0, s50, 16384
    s_nop 0
    buffer_load_dwordx4 v16, s[24:27], s54 offen sc1 lds
    s_add_u32 m0, s50, 17408
    s_nop 0
    buffer_load_dwordx4 v17, s[24:27], s54 offen sc1 lds
    s_add_u32 m0, s50, 18432
    s_nop 0
    buffer_load_dwordx4 v18, s[24:27], s54 offen sc1 lds
    s_add_u32 m0, s50, 19456
    s_nop 0
    buffer_load_dwordx4 v19, s[24:27], s54 offen sc1 lds
    s_add_u32 s54, s54, s6
    s_add_u32 m0, s50, 32768
    s_nop 0
    buffer_load_dwordx4 v16, s[24:27], s54 offen sc1 lds
    s_add_u32 m0, s50, 33792
    s_nop 0
    buffer_load_dwordx4 v17, s[24:27], s54 offen sc1 lds
    s_add_u32 m0, s50, 34816
    s_nop 0
    buffer_load_dwordx4 v18, s[24:27], s54 offen sc1 lds
    s_add_u32 m0, s50, 35840
    s_nop 0
    buffer_load_dwordx4 v19, s[24:27], s54 offen sc1 lds
    s_add_u32 s54, s54, s6
    s_add_u32 m0, s50, 49152
    s_nop 0
    buffer_load_dwordx4 v16, s[24:27], s54 offen sc1 lds
    s_add_u32 m0, s50, 50176
    s_nop 0
    buffer_load_dwordx4 v17, s[24:27], s54 offen sc1 lds
    s_add_u32 m0, s50, 51200
    s_nop 0
    buffer_load_dwordx4 v18, s[24:27], s54 offen sc1 lds
    s_add_u32 m0, s50, 52224
    s_nop 0
    buffer_load_dwordx4 v19, s[24:27], s54 offen sc1 lds
    s_add_u32 s54, s54, s6
    s_add_u32 s4, s8, 360448
    v_mov_b32 v62, 151888
    s_cmp_lg_u32 s48, 0
    s_cbranch_scc1 L_m_ot42
    s_mov_b32 s11, 0
    s_mov_b32 exec_lo, 0xffff
    s_mov_b32 exec_hi, 0
L_m_pl45:
    buffer_load_dword v60, v58, s[44:47], s4 offen sc1
    s_add_u32 s11, s11, 1
    s_cmp_gt_u32 s11, 131072
    s_cbranch_scc1 L_m_pk46
    s_waitcnt vmcnt(0)
    v_cmp_ne_u32 vcc, s15, v60
    s_nop 4
    s_cbranch_vccnz L_m_pl45
L_m_pk46:
    s_mov_b64 exec, -1
    v_mov_b32 v63, 1
    ds_write_b32 v62, v63
    s_branch L_m_dn43
L_m_ot42:
    s_mov_b32 s11, 0
L_m_lw44:
    ds_read_b32 v63, v62
    s_add_u32 s11, s11, 1
    s_cmp_gt_u32 s11, 2097152
    s_cbranch_scc1 L_m_dn43
    s_waitcnt lgkmcnt(0)
    v_readfirstlane_b32 s10, v63
    s_sleep 1
    s_cmp_eq_u32 s10, 0
    s_cbranch_scc1 L_m_lw44
L_m_dn43:
    s_waitcnt vmcnt(0)
    s_add_u32 m0, s49, 0
    s_nop 0
    buffer_load_dwordx4 v8, s[20:23], s53 offen sc1 lds
    s_add_u32 m0, s49, 4096
    s_nop 0
    buffer_load_dwordx4 v9, s[20:23], s53 offen sc1 lds
    s_add_u32 m0, s49, 8192
    s_nop 0
    buffer_load_dwordx4 v10, s[20:23], s53 offen sc1 lds
    s_add_u32 m0, s49, 12288
    s_nop 0
    buffer_load_dwordx4 v11, s[20:23], s53 offen sc1 lds
    s_add_u32 s53, s53, s9
    s_add_u32 m0, s49, 16384
    s_nop 0
    buffer_load_dwordx4 v8, s[20:23], s53 offen sc1 lds
    s_add_u32 m0, s49, 20480
    s_nop 0
    buffer_load_dwordx4 v9, s[20:23], s53 offen sc1 lds
    s_add_u32 m0, s49, 24576
    s_nop 0
    buffer_load_dwordx4 v10, s[20:23], s53 offen sc1 lds
    s_add_u32 m0, s49, 28672
    s_nop 0
    buffer_load_dwordx4 v11, s[20:23], s53 offen sc1 lds
    s_add_u32 s53, s53, s9
    s_add_u32 m0, s49, 32768
    s_nop 0
    buffer_load_dwordx4 v8, s[20:23], s53 offen sc1 lds
    s_add_u32 m0, s49, 36864
    s_nop 0
    buffer_load_dwordx4 v9, s[20:23], s53 offen sc1 lds
    s_add_u32 m0, s49, 40960
    s_nop 0
    buffer_load_dwordx4 v10, s[20:23], s53 offen sc1 lds
    s_add_u32 m0, s49, 45056
    s_nop 0
    buffer_load_dwordx4 v11, s[20:23], s53 offen sc1 lds
    s_add_u32 s53, s53, s9
    s_add_u32 m0, s49, 49152
    s_nop 0
    buffer_load_dwordx4 v8, s[20:23], s53 offen sc1 lds
    s_add_u32 m0, s49, 53248
    s_nop 0
    buffer_load_dwordx4 v9, s[20:23], s53 offen sc1 lds
    s_add_u32 m0, s49, 57344
    s_nop 0
    buffer_load_dwordx4 v10, s[20:23], s53 offen sc1 lds
    s_add_u32 m0, s49, 61440
    s_nop 0
    buffer_load_dwordx4 v11, s[20:23], s53 offen sc1 lds
    s_add_u32 s53, s53, s9
    s_mov_b32 s61, 0
    s_mov_b32 s63, 2
    s_mov_b32 s7, 88753152
    s_lshl_b32 s3, s48, 13
    s_add_u32 s3, s3, 131072
    v_add_u32 v76, s3, v3
    v_mov_b32 v78, 0xbdd2d3e8
    v_mov_b32 v79, 0xbdd2d3e8
    v_mov_b32 v80, 0xc0135761
    v_mov_b32 v81, 0xc0135761
    s_waitcnt vmcnt(12)
    s_barrier
    s_waitcnt vmcnt(8)
    s_barrier
    s_add_u32 m0, s49, 0
    s_nop 0
    buffer_load_dwordx4 v8, s[20:23], s53 offen sc1 lds
    s_add_u32 m0, s50, 0
    s_nop 0
    buffer_load_dwordx4 v16, s[24:27], s54 offen sc1 lds
    s_add_u32 m0, s49, 4096
    s_nop 0
    buffer_load_dwordx4 v9, s[20:23], s53 offen sc1 lds
    s_add_u32 m0, s50, 1024
    s_nop 0
    buffer_load_dwordx4 v17, s[24:27], s54 offen sc1 lds
    s_add_u32 m0, s49, 8192
    s_nop 0
    buffer_load_dwordx4 v10, s[20:23], s53 offen sc1 lds
    s_add_u32 m0, s50, 2048
    s_nop 0
    buffer_load_dwordx4 v18, s[24:27], s54 offen sc1 lds
    s_add_u32 m0, s49, 12288
    s_nop 0
    buffer_load_dwordx4 v11, s[20:23], s53 offen sc1 lds
    s_add_u32 m0, s50, 3072
    s_nop 0
    buffer_load_dwordx4 v19, s[24:27], s54 offen sc1 lds
    s_add_u32 s53, s53, s9
    s_add_u32 s54, s54, s6
    s_waitcnt vmcnt(12)
    s_barrier
    s_add_u32 m0, s49, 16384
    s_nop 0
    buffer_load_dwordx4 v8, s[20:23], s53 offen sc1 lds
    s_add_u32 m0, s50, 16384
    s_nop 0
    buffer_load_dwordx4 v16, s[24:27], s54 offen sc1 lds
    s_add_u32 m0, s49, 20480
    s_nop 0
    buffer_load_dwordx4 v9, s[20:23], s53 offen sc1 lds
    s_add_u32 m0, s50, 17408
    s_nop 0
    buffer_load_dwordx4 v17, s[24:27], s54 offen sc1 lds
    s_add_u32 m0, s49, 24576
    s_nop 0
    buffer_load_dwordx4 v10, s[20:23], s53 offen sc1 lds
    s_add_u32 m0, s50, 18432
    s_nop 0
    buffer_load_dwordx4 v18, s[24:27], s54 offen sc1 lds
    s_add_u32 m0, s49, 28672
    s_nop 0
    buffer_load_dwordx4 v11, s[20:23], s53 offen sc1 lds
    s_add_u32 m0, s50, 19456
    s_nop 0
    buffer_load_dwordx4 v19, s[24:27], s54 offen sc1 lds
    s_add_u32 s53, s53, s9
    s_add_u32 s54, s54, s6
    s_branch L_m_pslot2
L_m_ptop:
    s_bitcmp1_b32 s7, 0
    s_waitcnt vmcnt(16)
    s_barrier
    s_cbranch_scc1 L_m_pe0
L_m_pr0:
    s_lshr_b32 s7, s7, 1
    s_add_u32 s63, s63, 1
    s_add_u32 m0, s49, 0
    s_nop 0
    buffer_load_dwordx4 v8, s[20:23], s53 offen sc1 lds
    s_add_u32 m0, s50, 0
    s_nop 0
    buffer_load_dwordx4 v16, s[24:27], s54 offen sc1 lds
    s_add_u32 m0, s49, 4096
    s_nop 0
    buffer_load_dwordx4 v9, s[20:23], s53 offen sc1 lds
    s_add_u32 m0, s50, 1024
    s_nop 0
    buffer_load_dwordx4 v17, s[24:27], s54 offen sc1 lds
    s_add_u32 m0, s49, 8192
    s_nop 0
    buffer_load_dwordx4 v10, s[20:23], s53 offen sc1 lds
    s_add_u32 m0, s50, 2048
    s_nop 0
    buffer_load_dwordx4 v18, s[24:27], s54 offen sc1 lds
    s_add_u32 m0, s49, 12288
    s_nop 0
    buffer_load_dwordx4 v11, s[20:23], s53 offen sc1 lds
    s_add_u32 m0, s50, 3072
    s_nop 0
    buffer_load_dwordx4 v19, s[24:27], s54 offen sc1 lds
    s_add_u32 s53, s53, s9
    s_add_u32 s54, s54, s6
    s_bitcmp1_b32 s7, 0
    s_waitcnt vmcnt(16)
    s_barrier
    s_cbranch_scc1 L_m_pe1
L_m_pr1:
    s_lshr_b32 s7, s7, 1
    s_add_u32 s63, s63, 1
    s_add_u32 m0, s49, 16384
    s_nop 0
    buffer_load_dwordx4 v8, s[20:23], s53 offen sc1 lds
    s_add_u32 m0, s50, 16384
    s_nop 0
    buffer_load_dwordx4 v16, s[24:27], s54 offen sc1 lds
    s_add_u32 m0, s49, 20480
    s_nop 0
    buffer_load_dwordx4 v9, s[20:23], s53 offen sc1 lds
    s_add_u32 m0, s50, 17408
    s_nop 0
    buffer_load_dwordx4 v17, s[24:27], s54 offen sc1 lds
    s_add_u32 m0, s49, 24576
    s_nop 0
    buffer_load_dwordx4 v10, s[20:23], s53 offen sc1 lds
    s_add_u32 m0, s50, 18432
    s_nop 0
    buffer_load_dwordx4 v18, s[24:27], s54 offen sc1 lds
    s_add_u32 m0, s49, 28672
    s_nop 0
    buffer_load_dwordx4 v11, s[20:23], s53 offen sc1 lds
    s_add_u32 m0, s50, 19456
    s_nop 0
    buffer_load_dwordx4 v19, s[24:27], s54 offen sc1 lds
    s_add_u32 s53, s53, s9
    s_add_u32 s54, s54, s6
L_m_pslot2:
    s_bitcmp1_b32 s7, 0
    s_waitcnt vmcnt(16)
    s_barrier
    s_cbranch_scc1 L_m_pe2
L_m_pr2:
    s_lshr_b32 s7, s7, 1
    s_add_u32 s63, s63, 1
    s_add_u32 m0, s49, 32768
    s_nop 0
    buffer_load_dwordx4 v8, s[20:23], s53 offen sc1 lds
    s_add_u32 m0, s50, 32768
    s_nop 0
    buffer_load_dwordx4 v16, s[24:27], s54 offen sc1 lds
    s_add_u32 m0, s49, 36864
    s_nop 0
    buffer_load_dwordx4 v9, s[20:23], s53 offen sc1 lds
    s_add_u32 m0, s50, 33792
    s_nop 0
    buffer_load_dwordx4 v17, s[24:27], s54 offen sc1 lds
    s_add_u32 m0, s49, 40960
    s_nop 0
    buffer_load_dwordx4 v10, s[20:23], s53 offen sc1 lds
    s_add_u32 m0, s50, 34816
    s_nop 0
    buffer_load_dwordx4 v18, s[24:27], s54 offen sc1 lds
    s_add_u32 m0, s49, 45056
    s_nop 0
    buffer_load_dwordx4 v11, s[20:23], s53 offen sc1 lds
    s_add_u32 m0, s50, 35840
    s_nop 0
    buffer_load_dwordx4 v19, s[24:27], s54 offen sc1 lds
    s_add_u32 s53, s53, s9
    s_add_u32 s54, s54, s6
    s_bitcmp1_b32 s7, 0
    s_waitcnt vmcnt(16)
    s_barrier
    s_cbranch_scc1 L_m_pe3
L_m_pr3:
    s_lshr_b32 s7, s7, 1
    s_add_u32 s63, s63, 1
    s_add_u32 m0, s49, 49152
    s_nop 0
    buffer_load_dwordx4 v8, s[20:23], s53 offen sc1 lds
    s_add_u32 m0, s50, 49152
    s_nop 0
    buffer_load_dwordx4 v16, s[24:27], s54 offen sc1 lds
    s_add_u32 m0, s49, 53248
    s_nop 0
    buffer_load_dwordx4 v9, s[20:23], s53 offen sc1 lds
    s_add_u32 m0, s50, 50176
    s_nop 0
    buffer_load_dwordx4 v17, s[24:27], s54 offen sc1 lds
    s_add_u32 m0, s49, 57344
    s_nop 0
    buffer_load_dwordx4 v10, s[20:23], s53 offen sc1 lds
    s_add_u32 m0, s50, 51200
    s_nop 0
    buffer_load_dwordx4 v18, s[24:27], s54 offen sc1 lds
    s_add_u32 m0, s49, 61440
    s_nop 0
    buffer_load_dwordx4 v11, s[20:23], s53 offen sc1 lds
    s_add_u32 m0, s50, 52224
    s_nop 0
    buffer_load_dwordx4 v19, s[24:27], s54 offen sc1 lds
    s_add_u32 s53, s53, s9
    s_add_u32 s54, s54, s6
    s_cmp_lt_u32 s63, 60
    s_cbranch_scc1 L_m_ptop
    s_branch L_m_ptail
L_m_pe0:
    s_cmp_lg_u32 s63, 12
    s_cbranch_scc1 L_m_en47
    s_mov_b32 s53, 0
    s_mov_b32 s54, 0
    s_branch L_m_pr0
L_m_en47:
    s_cmp_lg_u32 s63, 16
    s_cbranch_scc1 L_m_en48
    s_cmp_lg_u32 s48, 0
    s_cbranch_scc1 L_m_np49
    ds_read_b128 v[32:35], v25
    ds_read_b128 v[36:39], v25 offset:1024
    s_waitcnt lgkmcnt(0)
    v_pk_add_f32 v[32:33], v[32:33], v[36:37]
    v_pk_add_f32 v[34:35], v[34:35], v[38:39]
    buffer_store_dwordx4 v[32:35], v24, s[44:47], 0 offen sc1
L_m_np49:
    s_branch L_m_pr0
L_m_en48:
    s_cmp_lg_u32 s63, 24
    s_cbranch_scc1 L_m_en50
    s_cmp_lg_u32 s48, 0
    s_cbranch_scc1 L_m_nf51
    s_mov_b64 s[10:11], exec
    s_mov_b64 exec, 1
    buffer_store_dword v29, v30, s[44:47], s55 offen sc1
    s_mov_b64 exec, s[10:11]
L_m_nf51:
    s_branch L_m_pr0
L_m_en50:
    s_waitcnt vmcnt(16)
    v_cmp_ne_u32 vcc, s15, v48
    s_nop 4
    s_cbranch_vccz L_m_ok53
    s_mov_b32 s62, 0
L_m_sp54:
    buffer_load_dword v48, v28, s[44:47], 0 offen sc1
    s_add_u32 s62, s62, 1
    s_cmp_gt_u32 s62, 131072
    s_cbranch_scc1 L_m_ok53
    s_waitcnt vmcnt(0)
    v_cmp_ne_u32 vcc, s15, v48
    s_nop 4
    s_cbranch_vccz L_m_ok53
    s_branch L_m_sp54
L_m_ok53:
    s_mov_b32 s53, 0
    s_mov_b32 s54, 0
    s_mov_b32 s6, 16384
    s_mov_b32 s9, 128
    s_mov_b32 s20, s80
    s_mov_b32 s21, s81
    s_mov_b32 s22, 8388608
    s_mov_b32 s23, 0x20000
    s_mov_b32 s24, s94
    s_mov_b32 s25, s95
    s_mov_b32 s26, 7340032
    s_mov_b32 s27, 0x20000
    v_mov_b32 v8, v12
    v_mov_b32 v16, v20
    v_mov_b32 v9, v13
    v_mov_b32 v17, v21
    v_mov_b32 v10, v14
    v_mov_b32 v18, v22
    v_mov_b32 v11, v15
    v_mov_b32 v19, v23
    s_branch L_m_pr0
L_m_en52:
L_m_pe1:
    s_waitcnt vmcnt(16)
    v_max3_u32 v60, v33, v35, v37
    v_max3_u32 v60, v60, v39, v41
    v_max3_u32 v60, v60, v43, v45
    v_max_u32 v60, v60, v47
    v_cmp_eq_u32 vcc, -1, v60
    s_nop 4
    s_cbranch_vccz L_m_ok56
    s_mov_b32 s62, 0
L_m_sp57:
    buffer_load_dwordx4 v[32:35], v26, s[44:47], 0 offen sc1
    buffer_load_dwordx4 v[36:39], v26, s[44:47], s57 offen sc1
    buffer_load_dwordx4 v[40:43], v26, s[44:47], s58 offen sc1
    buffer_load_dwordx4 v[44:47], v26, s[44:47], s59 offen sc1
    s_add_u32 s62, s62, 1
    s_cmp_gt_u32 s62, 131072
    s_cbranch_scc1 L_m_ok56
    s_waitcnt vmcnt(0)
    v_max3_u32 v60, v33, v35, v37
    v_max3_u32 v60, v60, v39, v41
    v_max3_u32 v60, v60, v43, v45
    v_max_u32 v60, v60, v47
    v_cmp_eq_u32 vcc, -1, v60
    s_nop 4
    s_cbranch_vccz L_m_ok56
    s_branch L_m_sp57
L_m_ok56:
    v_pk_add_f32 v[32:33], v[32:33], v[36:37]
    v_pk_add_f32 v[34:35], v[34:35], v[38:39]
    v_pk_add_f32 v[40:41], v[40:41], v[44:45]
    v_pk_add_f32 v[42:43], v[42:43], v[46:47]
    v_pk_add_f32 v[32:33], v[32:33], v[40:41]
    v_pk_add_f32 v[34:35], v[34:35], v[42:43]
    s_nop 1
    v_permlane32_swap_b32 v32, v34
    v_permlane32_swap_b32 v33, v35
    v_add_f32 v32, v32, v34
    v_add_f32 v33, v33, v35
    v_mov_b32 v34, v32
    v_mov_b32 v35, v33
    s_nop 1
    v_permlane16_swap_b32 v34, v32
    v_permlane16_swap_b32 v35, v33
    v_add_f32 v32, v32, v34
    v_add_f32 v33, v33, v35
    s_mov_b32 s10, 0x3a124925
    v_mul_f32 v32, s10, v32
    v_mul_f32 v34, v32, v32
    v_fma_f32 v33, v33, s10, -v34
    v_max_f32 v33, 0, v33
    v_add_f32 v33, 0x3727c5ac, v33
    v_rsq_f32 v34, v33
    s_nop 0
    v_mul_f32_e64 v35, -v32, v34
    ds_write_b64 v27, v[34:35]
    s_waitcnt lgkmcnt(0)
    s_branch L_m_pr1
L_m_en55:
L_m_pe2:
    buffer_load_dword v48, v28, s[44:47], 0 offen sc1
    s_branch L_m_pr2
L_m_en58:
L_m_pe3:
    buffer_load_dwordx4 v[32:35], v26, s[44:47], 0 offen sc1
    buffer_load_dwordx4 v[36:39], v26, s[44:47], s57 offen sc1
    buffer_load_dwordx4 v[40:43], v26, s[44:47], s58 offen sc1
    buffer_load_dwordx4 v[44:47], v26, s[44:47], s59 offen sc1
    s_branch L_m_pr3
L_m_en59:
L_m_ptail:
    s_waitcnt vmcnt(16)
    s_barrier
    s_lshl_b32 s4, s16, 7
    s_add_u32 s4, s4, 311296
    buffer_load_dword v48, v30, s[44:47], s4 offen sc1
    s_waitcnt vmcnt(9)
    s_barrier
    s_waitcnt vmcnt(0)
    s_barrier
    v_readfirstlane_b32 s3, v48
    s_nop 0
    s_cmp_eq_u32 s3, s15
    s_cbranch_scc1 L_m_wok60
    s_lshl_b32 s4, s16, 7
    s_add_u32 s4, s4, 311296
    s_mov_b32 s11, 0
    s_mov_b32 exec_lo, 0x1
    s_mov_b32 exec_hi, 0
L_m_pl61:
    buffer_load_dword v60, v30, s[44:47], s4 offen sc1
    s_add_u32 s11, s11, 1
    s_cmp_gt_u32 s11, 131072
    s_cbranch_scc1 L_m_pk62
    s_waitcnt vmcnt(0)
    v_cmp_ne_u32 vcc, s15, v60
    s_sleep 4
    s_cbranch_vccnz L_m_pl61
L_m_pk62:
    s_mov_b64 exec, -1
L_m_wok60:
    s_add_u32 s20, s94, 41943040
    s_addc_u32 s21, s95, 0
    s_mov_b32 s22, 3670016
    s_mov_b32 s23, 0x20000
    s_add_u32 s28, s94, 16777216
    s_addc_u32 s29, s95, 0
    s_mov_b32 s30, 7340032
    s_mov_b32 s31, 0x20000
    s_lshl_b32 s49, s48, 12
    s_lshl_b32 s50, s48, 11
    s_add_u32 s50, s50, 131072
    s_add_u32 s3, s12, s14
    s_and_b32 s3, s3, 0
    s_mul_i32 s3, s3, 28
    s_lshl_b32 s53, s3, 14
    s_lshl_b32 s54, s3, 13
    s_lshl_b32 s54, s13, 14
    s_lshl_b32 s6, s13, 15
    s_lshl_b32 s7, s13, 14
    s_add_u32 m0, s50, 0
    s_nop 0
    buffer_load_dwordx4 v56, s[20:23], s54 offen sc1 lds
    s_add_u32 m0, s50, 1024
    s_nop 0
    buffer_load_dwordx4 v57, s[20:23], s54 offen sc1 lds
    s_add_u32 s54, s54, 8192
    s_cmp_eq_u32 s54, s7
    s_cselect_b32 s3, 16384, 0
    s_add_u32 s54, s54, s3
    s_add_u32 m0, s50, 8192
    s_nop 0
    buffer_load_dwordx4 v56, s[20:23], s54 offen sc1 lds
    s_add_u32 m0, s50, 9216
    s_nop 0
    buffer_load_dwordx4 v57, s[20:23], s54 offen sc1 lds
    s_add_u32 s54, s54, 8192
    s_cmp_eq_u32 s54, s7
    s_cselect_b32 s3, 16384, 0
    s_add_u32 s54, s54, s3
    s_cmp_eq_u32 s13, 0
    s_cselect_b32 s54, 16384, 0
    s_cselect_b32 s53, 32768, 0
    s_add_u32 m0, s50, 16384
    s_nop 0
    buffer_load_dwordx4 v56, s[20:23], s54 offen sc1 lds
    s_add_u32 m0, s50, 17408
    s_nop 0
    buffer_load_dwordx4 v57, s[20:23], s54 offen sc1 lds
    s_add_u32 s54, s54, 8192
    s_cmp_eq_u32 s54, s7
    s_cselect_b32 s3, 16384, 0
    s_add_u32 s54, s54, s3
    s_add_u32 m0, s50, 24576
    s_nop 0
    buffer_load_dwordx4 v56, s[20:23], s54 offen sc1 lds
    s_add_u32 m0, s50, 25600
    s_nop 0
    buffer_load_dwordx4 v57, s[20:23], s54 offen sc1 lds
    s_add_u32 s54, s54, 8192
    s_cmp_eq_u32 s54, s7
    s_cselect_b32 s3, 16384, 0
    s_add_u32 s54, s54, s3
    v_mov_b32 v62, 98304
    ds_write_b32 v62, v30
    s_waitcnt lgkmcnt(0)
    s_barrier
    s_mov_b32 s24, s90
    s_mov_b32 s25, s91
    s_mov_b32 s26, 4194304
    s_mov_b32 s27, 0x20000
    s_add_u32 s32, s94, 25165824
    s_addc_u32 s33, s95, 0
    s_mov_b32 s34, 4194304
    s_mov_b32 s35, 0x20000
    s_add_u32 s36, s94, 8912896
    s_addc_u32 s37, s95, 0
    s_mov_b32 s38, 12288
    s_mov_b32 s39, 0x20000
    v_lshrrev_b32 v110, 3, v0
    v_and_b32 v111, 7, v0
    s_lshl_b32 s3, s12, 18
    s_lshl_b32 s19, s14, 7
    s_add_u32 s3, s3, s19
    v_lshlrev_b32 v112, 4, v111
    v_lshl_add_u32 v113, v110, 11, v112
    v_add_u32 v120, s3, v113
    s_add_u32 s19, s19, 10240
    v_add_u32 v121, s19, v112
    v_and_b32 v112, 7, v110
    v_xor_b32 v112, v112, v111
    v_lshlrev_b32 v112, 4, v112
    v_lshl_add_u32 v122, v110, 7, v112
    s_mov_b32 s9, 131072
    s_add_u32 s4, s8, 425984
    v_lshlrev_b32 v62, 11, v1
    s_mov_b32 s63, 6
    s_waitcnt vmcnt(0)
    s_barrier
    s_barrier
    s_cmp_lg_u32 s48, 0
    s_cbranch_scc1 L_m_nf63
    s_mov_b64 exec, 3
    buffer_store_dword v29, v62, s[44:47], s56 offen sc1
    s_mov_b64 exec, -1
L_m_nf63:
    s_sub_u32 s50, s50, 65536
    s_add_u32 m0, s50, 0
    s_nop 0
    buffer_load_dwordx4 v56, s[20:23], s54 offen sc1 lds
    s_add_u32 m0, s50, 1024
    s_nop 0
    buffer_load_dwordx4 v57, s[20:23], s54 offen sc1 lds
    s_add_u32 s54, s54, 8192
    s_cmp_eq_u32 s54, s7
    s_cselect_b32 s3, 16384, 0
    s_add_u32 s54, s54, s3
    s_add_u32 m0, s50, 8192
    s_nop 0
    buffer_load_dwordx4 v56, s[20:23], s54 offen sc1 lds
    s_add_u32 m0, s50, 9216
    s_nop 0
    buffer_load_dwordx4 v57, s[20:23], s54 offen sc1 lds
    s_add_u32 s54, s54, 8192
    s_cmp_eq_u32 s54, s7
    s_cselect_b32 s3, 16384, 0
    s_add_u32 s54, s54, s3
    s_add_u32 m0, s50, 16384
    s_nop 0
    buffer_load_dwordx4 v56, s[20:23], s54 offen sc1 lds
    s_add_u32 m0, s50, 17408
    s_nop 0
    buffer_load_dwordx4 v57, s[20:23], s54 offen sc1 lds
    s_add_u32 s54, s54, 8192
    s_cmp_eq_u32 s54, s7
    s_cselect_b32 s3, 16384, 0
    s_add_u32 s54, s54, s3
    s_add_u32 m0, s50, 24576
    s_nop 0
    buffer_load_dwordx4 v56, s[20:23], s54 offen sc1 lds
    s_add_u32 m0, s50, 25600
    s_nop 0
    buffer_load_dwordx4 v57, s[20:23], s54 offen sc1 lds
    s_add_u32 s54, s54, 8192
    s_cmp_eq_u32 s54, s7
    s_cselect_b32 s3, 16384, 0
    s_add_u32 s54, s54, s3
    s_add_u32 m0, s50, 32768
    s_nop 0
    buffer_load_dwordx4 v56, s[20:23], s54 offen sc1 lds
    s_add_u32 m0, s50, 33792
    s_nop 0
    buffer_load_dwordx4 v57, s[20:23], s54 offen sc1 lds
    s_add_u32 s54, s54, 8192
    s_cmp_eq_u32 s54, s7
    s_cselect_b32 s3, 16384, 0
    s_add_u32 s54, s54, s3
    s_add_u32 m0, s50, 40960
    s_nop 0
    buffer_load_dwordx4 v56, s[20:23], s54 offen sc1 lds
    s_add_u32 m0, s50, 41984
    s_nop 0
    buffer_load_dwordx4 v57, s[20:23], s54 offen sc1 lds
    s_add_u32 s54, s54, 8192
    s_cmp_eq_u32 s54, s7
    s_cselect_b32 s3, 16384, 0
    s_add_u32 s54, s54, s3
    s_add_u32 m0, s50, 49152
    s_nop 0
    buffer_load_dwordx4 v56, s[20:23], s54 offen sc1 lds
    s_add_u32 m0, s50, 50176
    s_nop 0
    buffer_load_dwordx4 v57, s[20:23], s54 offen sc1 lds
    s_add_u32 s54, s54, 8192
    s_cmp_eq_u32 s54, s7
    s_cselect_b32 s3, 16384, 0
    s_add_u32 s54, s54, s3
    s_add_u32 m0, s50, 57344
    s_nop 0
    buffer_load_dwordx4 v56, s[20:23], s54 offen sc1 lds
    s_add_u32 m0, s50, 58368
    s_nop 0
    buffer_load_dwordx4 v57, s[20:23], s54 offen sc1 lds
    s_add_u32 s54, s54, 8192
    s_cmp_eq_u32 s54, s7
    s_cselect_b32 s3, 16384, 0
    s_add_u32 s54, s54, s3
    s_add_u32 s50, s50, 65536
    s_mov_b32 s11, 0
    s_mov_b32 exec_lo, 0x3fff
    s_mov_b32 exec_hi, 0
L_m_pl64:
    buffer_load_dword v60, v58, s[44:47], s4 offen sc1
    s_add_u32 s11, s11, 1
    s_cmp_gt_u32 s11, 131072
    s_cbranch_scc1 L_m_pk65
    s_waitcnt vmcnt(0)
    v_cmp_ne_u32 vcc, s15, v60
    s_nop 4
    s_cbranch_vccnz L_m_pl64
L_m_pk65:
    s_mov_b64 exec, -1
    s_add_u32 m0, s49, 32768
    s_nop 0
    buffer_load_dwordx4 v52, s[28:31], s53 offen sc1 lds
    s_add_u32 m0, s49, 33792
    s_nop 0
    buffer_load_dwordx4 v53, s[28:31], s53 offen sc1 lds
    s_add_u32 m0, s49, 34816
    s_nop 0
    buffer_load_dwordx4 v54, s[28:31], s53 offen sc1 lds
    s_add_u32 m0, s49, 35840
    s_nop 0
    buffer_load_dwordx4 v55, s[28:31], s53 offen sc1 lds
    s_add_u32 s53, s53, 16384
    s_cmp_eq_u32 s53, s6
    s_cselect_b32 s3, 32768, 0
    s_add_u32 s53, s53, s3
    s_add_u32 m0, s49, 49152
    s_nop 0
    buffer_load_dwordx4 v52, s[28:31], s53 offen sc1 lds
    s_add_u32 m0, s49, 50176
    s_nop 0
    buffer_load_dwordx4 v53, s[28:31], s53 offen sc1 lds
    s_add_u32 m0, s49, 51200
    s_nop 0
    buffer_load_dwordx4 v54, s[28:31], s53 offen sc1 lds
    s_add_u32 m0, s49, 52224
    s_nop 0
    buffer_load_dwordx4 v55, s[28:31], s53 offen sc1 lds
    s_add_u32 s53, s53, 16384
    s_cmp_eq_u32 s53, s6
    s_cselect_b32 s3, 32768, 0
    s_add_u32 s53, s53, s3
    s_add_u32 m0, s49, 0
    s_nop 0
    buffer_load_dwordx4 v52, s[28:31], s53 offen sc1 lds
    s_add_u32 m0, s49, 1024
    s_nop 0
    buffer_load_dwordx4 v53, s[28:31], s53 offen sc1 lds
    s_add_u32 m0, s49, 2048
    s_nop 0
    buffer_load_dwordx4 v54, s[28:31], s53 offen sc1 lds
    s_add_u32 m0, s49, 3072
    s_nop 0
    buffer_load_dwordx4 v55, s[28:31], s53 offen sc1 lds
    s_add_u32 s53, s53, 16384
    s_cmp_eq_u32 s53, s6
    s_cselect_b32 s3, 32768, 0
    s_add_u32 s53, s53, s3
    s_mov_b32 s63, 3
    s_branch L_m_g3k1
L_m_pspare:
    s_mov_b32 s20, s78
    s_mov_b32 s21, s79
    s_mov_b32 s22, 7340032
    s_mov_b32 s23, 0x20000
    s_mov_b32 s24, s80
    s_mov_b32 s25, s81
    s_mov_b32 s26, 8388608
    s_mov_b32 s27, 0x20000
    s_mov_b32 s28, s84
    s_mov_b32 s29, s85
    s_mov_b32 s30, 3670016
    s_mov_b32 s31, 0x20000
    s_sub_u32 s3, s17, 28
    s_lshl_b32 s3, s3, 3
    s_add_u32 s48, s3, s18
    s_lshl_b32 s3, s48, 4
    v_lshrrev_b32 v2, 2, v1
    v_add_u32 v2, s3, v2
    v_mul_u32_u24 v2, 7168, v2
    v_and_b32 v3, 3, v1
    v_lshl_add_u32 v2, v3, 9, v2
    s_and_b32 s3, s16, 1
    s_mul_i32 s3, s3, 1536
    s_add_u32 s49, s3, 384
    s_add_u32 s3, s49, 3584
    buffer_load_dword v10, v2, s[20:23], s3 offen
    s_add_u32 s3, s49, 3673600
    buffer_load_dword v10, v2, s[20:23], s3 offen
    s_add_u32 s3, s49, 0
    buffer_load_dword v10, v2, s[20:23], s3 offen
    s_add_u32 s3, s49, 3670016
    buffer_load_dword v10, v2, s[20:23], s3 offen
    s_add_u32 s24, s94, 41943040
    s_addc_u32 s25, s95, 0
    s_mov_b32 s26, 3670016
    s_mov_b32 s27, 0x20000
    s_sub_u32 s3, s17, 28
    s_lshl_b32 s19, s16, 2
    s_add_u32 s3, s3, s19
    s_lshl_b32 s3, s3, 2
    s_add_u32 s3, s3, s18
    s_sub_u32 s3, s3, 4
    s_mul_i32 s49, s3, 28672
    s_mul_i32 s50, s3, 1792
    v_lshlrev_b32 v2, 4, v1
    v_lshrrev_b32 v3, 3, v1
    s_mov_b32 s3, 229376
    v_mul_lo_u32 v3, v3, s3
    v_and_b32 v4, 7, v1
    v_lshl_add_u32 v3, v4, 4, v3
    v_add_u32 v4, 1835008, v3
    buffer_load_dwordx4 v[64:67], v2, s[28:31], s49 offen nt
    s_add_u32 s49, s49, 1024
    buffer_load_dwordx4 v[68:71], v2, s[28:31], s49 offen nt
    s_add_u32 s49, s49, 1024
    buffer_load_dwordx4 v[72:75], v2, s[28:31], s49 offen nt
    s_add_u32 s49, s49, 1024
    buffer_load_dwordx4 v[76:79], v2, s[28:31], s49 offen nt
    s_add_u32 s49, s49, 1024
    buffer_load_dwordx4 v[80:83], v2, s[28:31], s49 offen nt
    s_add_u32 s49, s49, 1024
    buffer_load_dwordx4 v[84:87], v2, s[28:31], s49 offen nt
    s_add_u32 s49, s49, 1024
    buffer_load_dwordx4 v[88:91], v2, s[28:31], s49 offen nt
    s_add_u32 s49, s49, 1024
    s_waitcnt vmcnt(6)
    buffer_store_dwordx4 v[64:67], v3, s[24:27], s50 offen offset:0 sc1
    s_waitcnt vmcnt(6)
    buffer_store_dwordx4 v[68:71], v4, s[24:27], s50 offen offset:0 sc1
    s_waitcnt vmcnt(6)
    buffer_store_dwordx4 v[72:75], v3, s[24:27], s50 offen offset:128 sc1
    s_waitcnt vmcnt(6)
    buffer_store_dwordx4 v[76:79], v4, s[24:27], s50 offen offset:128 sc1
    s_waitcnt vmcnt(6)
    buffer_store_dwordx4 v[80:83], v3, s[24:27], s50 offen offset:256 sc1
    s_waitcnt vmcnt(6)
    buffer_store_dwordx4 v[84:87], v4, s[24:27], s50 offen offset:256 sc1
    s_waitcnt vmcnt(6)
    buffer_store_dwordx4 v[88:91], v3, s[24:27], s50 offen offset:384 sc1
    s_waitcnt vmcnt(0)
    buffer_load_dwordx4 v[64:67], v2, s[28:31], s49 offen nt
    s_add_u32 s49, s49, 1024
    buffer_load_dwordx4 v[68:71], v2, s[28:31], s49 offen nt
    s_add_u32 s49, s49, 1024
    buffer_load_dwordx4 v[72:75], v2, s[28:31], s49 offen nt
    s_add_u32 s49, s49, 1024
    buffer_load_dwordx4 v[76:79], v2, s[28:31], s49 offen nt
    s_add_u32 s49, s49, 1024
    buffer_load_dwordx4 v[80:83], v2, s[28:31], s49 offen nt
    s_add_u32 s49, s49, 1024
    buffer_load_dwordx4 v[84:87], v2, s[28:31], s49 offen nt
    s_add_u32 s49, s49, 1024
    buffer_load_dwordx4 v[88:91], v2, s[28:31], s49 offen nt
    s_add_u32 s49, s49, 1024
    s_waitcnt vmcnt(6)
    buffer_store_dwordx4 v[64:67], v4, s[24:27], s50 offen offset:384 sc1
    s_waitcnt vmcnt(6)
    buffer_store_dwordx4 v[68:71], v3, s[24:27], s50 offen offset:512 sc1
    s_waitcnt vmcnt(6)
    buffer_store_dwordx4 v[72:75], v4, s[24:27], s50 offen offset:512 sc1
    s_waitcnt vmcnt(6)
    buffer_store_dwordx4 v[76:79], v3, s[24:27], s50 offen offset:640 sc1
    s_waitcnt vmcnt(6)
    buffer_store_dwordx4 v[80:83], v4, s[24:27], s50 offen offset:640 sc1
    s_waitcnt vmcnt(6)
    buffer_store_dwordx4 v[84:87], v3, s[24:27], s50 offen offset:768 sc1
    s_waitcnt vmcnt(6)
    buffer_store_dwordx4 v[88:91], v4, s[24:27], s50 offen offset:768 sc1
    s_waitcnt vmcnt(0)
    buffer_load_dwordx4 v[64:67], v2, s[28:31], s49 offen nt
    s_add_u32 s49, s49, 1024
    buffer_load_dwordx4 v[68:71], v2, s[28:31], s49 offen nt
    s_add_u32 s49, s49, 1024
    buffer_load_dwordx4 v[72:75], v2, s[28:31], s49 offen nt
    s_add_u32 s49, s49, 1024
    buffer_load_dwordx4 v[76:79], v2, s[28:31], s49 offen nt
    s_add_u32 s49, s49, 1024
    buffer_load_dwordx4 v[80:83], v2, s[28:31], s49 offen nt
    s_add_u32 s49, s49, 1024
    buffer_load_dwordx4 v[84:87], v2, s[28:31], s49 offen nt
    s_add_u32 s49, s49, 1024
    buffer_load_dwordx4 v[88:91], v2, s[28:31], s49 offen nt
    s_add_u32 s49, s49, 1024
    s_waitcnt vmcnt(6)
    buffer_store_dwordx4 v[64:67], v3, s[24:27], s50 offen offset:896 sc1
    s_waitcnt vmcnt(6)
    buffer_store_dwordx4 v[68:71], v4, s[24:27], s50 offen offset:896 sc1
    s_waitcnt vmcnt(6)
    buffer_store_dwordx4 v[72:75], v3, s[24:27], s50 offen offset:1024 sc1
    s_waitcnt vmcnt(6)
    buffer_store_dwordx4 v[76:79], v4, s[24:27], s50 offen offset:1024 sc1
    s_waitcnt vmcnt(6)
    buffer_store_dwordx4 v[80:83], v3, s[24:27], s50 offen offset:1152 sc1
    s_waitcnt vmcnt(6)
    buffer_store_dwordx4 v[84:87], v4, s[24:27], s50 offen offset:1152 sc1
    s_waitcnt vmcnt(6)
    buffer_store_dwordx4 v[88:91], v3, s[24:27], s50 offen offset:1280 sc1
    s_waitcnt vmcnt(0)
    buffer_load_dwordx4 v[64:67], v2, s[28:31], s49 offen nt
    s_add_u32 s49, s49, 1024
    buffer_load_dwordx4 v[68:71], v2, s[28:31], s49 offen nt
    s_add_u32 s49, s49, 1024
    buffer_load_dwordx4 v[72:75], v2, s[28:31], s49 offen nt
    s_add_u32 s49, s49, 1024
    buffer_load_dwordx4 v[76:79], v2, s[28:31], s49 offen nt
    s_add_u32 s49, s49, 1024
    buffer_load_dwordx4 v[80:83], v2, s[28:31], s49 offen nt
    s_add_u32 s49, s49, 1024
    buffer_load_dwordx4 v[84:87], v2, s[28:31], s49 offen nt
    s_add_u32 s49, s49, 1024
    buffer_load_dwordx4 v[88:91], v2, s[28:31], s49 offen nt
    s_add_u32 s49, s49, 1024
    s_waitcnt vmcnt(6)
    buffer_store_dwordx4 v[64:67], v4, s[24:27], s50 offen offset:1280 sc1
    s_waitcnt vmcnt(6)
    buffer_store_dwordx4 v[68:71], v3, s[24:27], s50 offen offset:1408 sc1
    s_waitcnt vmcnt(6)
    buffer_store_dwordx4 v[72:75], v4, s[24:27], s50 offen offset:1408 sc1
    s_waitcnt vmcnt(6)
    buffer_store_dwordx4 v[76:79], v3, s[24:27], s50 offen offset:1536 sc1
    s_waitcnt vmcnt(6)
    buffer_store_dwordx4 v[80:83], v4, s[24:27], s50 offen offset:1536 sc1
    s_waitcnt vmcnt(6)
    buffer_store_dwordx4 v[84:87], v3, s[24:27], s50 offen offset:1664 sc1
    s_waitcnt vmcnt(6)
    buffer_store_dwordx4 v[88:91], v4, s[24:27], s50 offen offset:1664 sc1
    s_waitcnt vmcnt(0)
    v_mov_b32 v62, 151904
    v_mov_b32 v63, 1
    s_waitcnt lgkmcnt(0)
    s_mov_b64 s[10:11], exec
    s_mov_b64 exec, 1
    ds_add_u32 v62, v63
    s_mov_b64 exec, s[10:11]
    s_mov_b32 s11, 0
L_m_ls67:
    ds_read_b32 v63, v62
    s_add_u32 s11, s11, 1
    s_cmp_gt_u32 s11, 1048576
    s_cbranch_scc1 L_m_lk68
    s_waitcnt lgkmcnt(0)
    v_readfirstlane_b32 s10, v63
    s_sleep 1
    s_cmp_lt_u32 s10, 4
    s_cbranch_scc1 L_m_ls67
L_m_lk68:
    s_sub_u32 s48, s18, 4
    s_cmp_lg_u32 s48, 0
    s_cbranch_scc1 L_m_nw69
    s_mov_b32 s4, 296960
    s_mov_b32 s5, 311296
    v_lshlrev_b32 v62, 7, v1
    s_mov_b64 exec, 1
    v_mov_b32 v63, 1
    buffer_atomic_add v63, v30, s[44:47], s4 offen sc0 sc1
    s_add_u32 s10, s15, 31
    s_waitcnt vmcnt(0)
    v_readfirstlane_b32 s11, v63
    s_mov_b64 exec, 255
    s_cmp_lg_u32 s11, s10
    s_cbranch_scc1 L_m_ar70
    buffer_store_dword v29, v62, s[44:47], s5 offen sc1
L_m_ar70:
    s_mov_b64 exec, -1
L_m_nw69:
    s_barrier
    s_lshl_b32 s4, s16, 7
    s_add_u32 s4, s4, 311296
    s_mov_b32 s11, 0
    s_mov_b32 exec_lo, 0x1
    s_mov_b32 exec_hi, 0
L_m_pl72:
    buffer_load_dword v60, v30, s[44:47], s4 offen sc1
    s_add_u32 s11, s11, 1
    s_cmp_gt_u32 s11, 131072
    s_cbranch_scc1 L_m_pk73
    s_waitcnt vmcnt(0)
    v_cmp_ne_u32 vcc, s15, v60
    s_sleep 4
    s_cbranch_vccnz L_m_pl72
L_m_pk73:
    s_mov_b64 exec, -1
L_m_wok71:
    s_add_u32 s20, s94, 41943040
    s_addc_u32 s21, s95, 0
    s_mov_b32 s22, 3670016
    s_mov_b32 s23, 0x20000
    s_add_u32 s28, s94, 16777216
    s_addc_u32 s29, s95, 0
    s_mov_b32 s30, 7340032
    s_mov_b32 s31, 0x20000
    s_lshl_b32 s49, s48, 12
    s_lshl_b32 s50, s48, 11
    s_add_u32 s50, s50, 131072
    s_add_u32 s3, s12, s14
    s_and_b32 s3, s3, 0
    s_mul_i32 s3, s3, 28
    s_lshl_b32 s53, s3, 14
    s_lshl_b32 s54, s3, 13
    s_mov_b32 s6, -1
    s_mov_b32 s7, -1
    s_add_u32 m0, s50, 0
    s_nop 0
    buffer_load_dwordx4 v56, s[20:23], s54 offen sc1 lds
    s_add_u32 m0, s50, 1024
    s_nop 0
    buffer_load_dwordx4 v57, s[20:23], s54 offen sc1 lds
    s_add_u32 s54, s54, 8192
    s_cmp_eq_u32 s54, s7
    s_cselect_b32 s3, 16384, 0
    s_add_u32 s54, s54, s3
    s_add_u32 m0, s50, 8192
    s_nop 0
    buffer_load_dwordx4 v56, s[20:23], s54 offen sc1 lds
    s_add_u32 m0, s50, 9216
    s_nop 0
    buffer_load_dwordx4 v57, s[20:23], s54 offen sc1 lds
    s_add_u32 s54, s54, 8192
    s_cmp_eq_u32 s54, s7
    s_cselect_b32 s3, 16384, 0
    s_add_u32 s54, s54, s3
    s_add_u32 m0, s50, 16384
    s_nop 0
    buffer_load_dwordx4 v56, s[20:23], s54 offen sc1 lds
    s_add_u32 m0, s50, 17408
    s_nop 0
    buffer_load_dwordx4 v57, s[20:23], s54 offen sc1 lds
    s_add_u32 s54, s54, 8192
    s_cmp_eq_u32 s54, s7
    s_cselect_b32 s3, 16384, 0
    s_add_u32 s54, s54, s3
    s_add_u32 m0, s50, 24576
    s_nop 0
    buffer_load_dwordx4 v56, s[20:23], s54 offen sc1 lds
    s_add_u32 m0, s50, 25600
    s_nop 0
    buffer_load_dwordx4 v57, s[20:23], s54 offen sc1 lds
    s_add_u32 s54, s54, 8192
    s_cmp_eq_u32 s54, s7
    s_cselect_b32 s3, 16384, 0
    s_add_u32 s54, s54, s3
    s_sub_u32 s50, s50, 65536
    s_add_u32 m0, s50, 0
    s_nop 0
    buffer_load_dwordx4 v56, s[20:23], s54 offen sc1 lds
    s_add_u32 m0, s50, 1024
    s_nop 0
    buffer_load_dwordx4 v57, s[20:23], s54 offen sc1 lds
    s_add_u32 s54, s54, 8192
    s_cmp_eq_u32 s54, s7
    s_cselect_b32 s3, 16384, 0
    s_add_u32 s54, s54, s3
    s_add_u32 m0, s50, 8192
    s_nop 0
    buffer_load_dwordx4 v56, s[20:23], s54 offen sc1 lds
    s_add_u32 m0, s50, 9216
    s_nop 0
    buffer_load_dwordx4 v57, s[20:23], s54 offen sc1 lds
    s_add_u32 s54, s54, 8192
    s_cmp_eq_u32 s54, s7
    s_cselect_b32 s3, 16384, 0
    s_add_u32 s54, s54, s3
    s_add_u32 m0, s50, 16384
    s_nop 0
    buffer_load_dwordx4 v56, s[20:23], s54 offen sc1 lds
    s_add_u32 m0, s50, 17408
    s_nop 0
    buffer_load_dwordx4 v57, s[20:23], s54 offen sc1 lds
    s_add_u32 s54, s54, 8192
    s_cmp_eq_u32 s54, s7
    s_cselect_b32 s3, 16384, 0
    s_add_u32 s54, s54, s3
    s_add_u32 m0, s50, 24576
    s_nop 0
    buffer_load_dwordx4 v56, s[20:23], s54 offen sc1 lds
    s_add_u32 m0, s50, 25600
    s_nop 0
    buffer_load_dwordx4 v57, s[20:23], s54 offen sc1 lds
    s_add_u32 s54, s54, 8192
    s_cmp_eq_u32 s54, s7
    s_cselect_b32 s3, 16384, 0
    s_add_u32 s54, s54, s3
    s_add_u32 m0, s50, 32768
    s_nop 0
    buffer_load_dwordx4 v56, s[20:23], s54 offen sc1 lds
    s_add_u32 m0, s50, 33792
    s_nop 0
    buffer_load_dwordx4 v57, s[20:23], s54 offen sc1 lds
    s_add_u32 s54, s54, 8192
    s_cmp_eq_u32 s54, s7
    s_cselect_b32 s3, 16384, 0
    s_add_u32 s54, s54, s3
    s_add_u32 m0, s50, 40960
    s_nop 0
    buffer_load_dwordx4 v56, s[20:23], s54 offen sc1 lds
    s_add_u32 m0, s50, 41984
    s_nop 0
    buffer_load_dwordx4 v57, s[20:23], s54 offen sc1 lds
    s_add_u32 s54, s54, 8192
    s_cmp_eq_u32 s54, s7
    s_cselect_b32 s3, 16384, 0
    s_add_u32 s54, s54, s3
    s_add_u32 m0, s50, 49152
    s_nop 0
    buffer_load_dwordx4 v56, s[20:23], s54 offen sc1 lds
    s_add_u32 m0, s50, 50176
    s_nop 0
    buffer_load_dwordx4 v57, s[20:23], s54 offen sc1 lds
    s_add_u32 s54, s54, 8192
    s_cmp_eq_u32 s54, s7
    s_cselect_b32 s3, 16384, 0
    s_add_u32 s54, s54, s3
    s_add_u32 m0, s50, 57344
    s_nop 0
    buffer_load_dwordx4 v56, s[20:23], s54 offen sc1 lds
    s_add_u32 m0, s50, 58368
    s_nop 0
    buffer_load_dwordx4 v57, s[20:23], s54 offen sc1 lds
    s_add_u32 s54, s54, 8192
    s_cmp_eq_u32 s54, s7
    s_cselect_b32 s3, 16384, 0
    s_add_u32 s54, s54, s3
    s_add_u32 s50, s50, 65536
L_m_pg3:
    s_mov_b32 s24, s90
    s_mov_b32 s25, s91
    s_mov_b32 s26, 4194304
    s_mov_b32 s27, 0x20000
    s_add_u32 s32, s94, 25165824
    s_addc_u32 s33, s95, 0
    s_mov_b32 s34, 4194304
    s_mov_b32 s35, 0x20000
    s_add_u32 s36, s94, 8912896
    s_addc_u32 s37, s95, 0
    s_mov_b32 s38, 12288
    s_mov_b32 s39, 0x20000
    v_lshrrev_b32 v110, 3, v0
    v_and_b32 v111, 7, v0
    s_lshl_b32 s3, s12, 18
    s_lshl_b32 s19, s14, 7
    s_add_u32 s3, s3, s19
    v_lshlrev_b32 v112, 4, v111
    v_lshl_add_u32 v113, v110, 11, v112
    v_add_u32 v120, s3, v113
    s_add_u32 s19, s19, 10240
    v_add_u32 v121, s19, v112
    v_and_b32 v112, 7, v110
    v_xor_b32 v112, v112, v111
    v_lshlrev_b32 v112, 4, v112
    v_lshl_add_u32 v122, v110, 7, v112
    s_mov_b32 s9, 131072
    s_add_u32 s4, s8, 425984
    s_mov_b32 s11, 0
    s_mov_b32 exec_lo, 0x3fff
    s_mov_b32 exec_hi, 0
L_m_pl74:
    buffer_load_dword v60, v58, s[44:47], s4 offen sc1
    s_add_u32 s11, s11, 1
    s_cmp_gt_u32 s11, 131072
    s_cbranch_scc1 L_m_pk75
    s_waitcnt vmcnt(0)
    v_cmp_ne_u32 vcc, s15, v60
    s_nop 4
    s_cbranch_vccnz L_m_pl74
L_m_pk75:
    s_mov_b64 exec, -1
    s_add_u32 m0, s49, 0
    s_nop 0
    buffer_load_dwordx4 v52, s[28:31], s53 offen sc1 lds
    s_add_u32 m0, s49, 1024
    s_nop 0
    buffer_load_dwordx4 v53, s[28:31], s53 offen sc1 lds
    s_add_u32 m0, s49, 2048
    s_nop 0
    buffer_load_dwordx4 v54, s[28:31], s53 offen sc1 lds
    s_add_u32 m0, s49, 3072
    s_nop 0
    buffer_load_dwordx4 v55, s[28:31], s53 offen sc1 lds
    s_add_u32 s53, s53, 16384
    s_cmp_eq_u32 s53, s6
    s_cselect_b32 s3, 32768, 0
    s_add_u32 s53, s53, s3
    s_add_u32 m0, s49, 16384
    s_nop 0
    buffer_load_dwordx4 v52, s[28:31], s53 offen sc1 lds
    s_add_u32 m0, s49, 17408
    s_nop 0
    buffer_load_dwordx4 v53, s[28:31], s53 offen sc1 lds
    s_add_u32 m0, s49, 18432
    s_nop 0
    buffer_load_dwordx4 v54, s[28:31], s53 offen sc1 lds
    s_add_u32 m0, s49, 19456
    s_nop 0
    buffer_load_dwordx4 v55, s[28:31], s53 offen sc1 lds
    s_add_u32 s53, s53, 16384
    s_cmp_eq_u32 s53, s6
    s_cselect_b32 s3, 32768, 0
    s_add_u32 s53, s53, s3
    s_add_u32 m0, s49, 32768
    s_nop 0
    buffer_load_dwordx4 v52, s[28:31], s53 offen sc1 lds
    s_add_u32 m0, s49, 33792
    s_nop 0
    buffer_load_dwordx4 v53, s[28:31], s53 offen sc1 lds
    s_add_u32 m0, s49, 34816
    s_nop 0
    buffer_load_dwordx4 v54, s[28:31], s53 offen sc1 lds
    s_add_u32 m0, s49, 35840
    s_nop 0
    buffer_load_dwordx4 v55, s[28:31], s53 offen sc1 lds
    s_add_u32 s53, s53, 16384
    s_cmp_eq_u32 s53, s6
    s_cselect_b32 s3, 32768, 0
    s_add_u32 s53, s53, s3
    s_add_u32 m0, s49, 49152
    s_nop 0
    buffer_load_dwordx4 v52, s[28:31], s53 offen sc1 lds
    s_add_u32 m0, s49, 50176
    s_nop 0
    buffer_load_dwordx4 v53, s[28:31], s53 offen sc1 lds
    s_add_u32 m0, s49, 51200
    s_nop 0
    buffer_load_dwordx4 v54, s[28:31], s53 offen sc1 lds
    s_add_u32 m0, s49, 52224
    s_nop 0
    buffer_load_dwordx4 v55, s[28:31], s53 offen sc1 lds
    s_add_u32 s53, s53, 16384
    s_cmp_eq_u32 s53, s6
    s_cselect_b32 s3, 32768, 0
    s_add_u32 s53, s53, s3
    s_mov_b32 s63, 3
    s_waitcnt vmcnt(12)
    s_barrier
    s_waitcnt vmcnt(8)
    s_barrier
    s_add_u32 m0, s49, 0
    s_nop 0
    buffer_load_dwordx4 v52, s[28:31], s53 offen sc1 lds
    s_add_u32 m0, s49, 1024
    s_nop 0
    buffer_load_dwordx4 v53, s[28:31], s53 offen sc1 lds
    s_add_u32 m0, s49, 2048
    s_nop 0
    buffer_load_dwordx4 v54, s[28:31], s53 offen sc1 lds
    s_add_u32 m0, s49, 3072
    s_nop 0
    buffer_load_dwordx4 v55, s[28:31], s53 offen sc1 lds
    s_add_u32 s53, s53, 16384
    s_cmp_eq_u32 s53, s6
    s_cselect_b32 s3, 32768, 0
    s_add_u32 s53, s53, s3
L_m_g3k1:
    s_waitcnt vmcnt(8)
    s_barrier
    s_add_u32 m0, s49, 16384
    s_nop 0
    buffer_load_dwordx4 v52, s[28:31], s53 offen sc1 lds
    s_add_u32 m0, s49, 17408
    s_nop 0
    buffer_load_dwordx4 v53, s[28:31], s53 offen sc1 lds
    s_add_u32 m0, s49, 18432
    s_nop 0
    buffer_load_dwordx4 v54, s[28:31], s53 offen sc1 lds
    s_add_u32 m0, s49, 19456
    s_nop 0
    buffer_load_dwordx4 v55, s[28:31], s53 offen sc1 lds
    s_add_u32 s53, s53, 16384
    s_cmp_eq_u32 s53, s6
    s_cselect_b32 s3, 32768, 0
    s_add_u32 s53, s53, s3
    s_waitcnt vmcnt(8)
    s_barrier
    s_add_u32 m0, s49, 32768
    s_nop 0
    buffer_load_dwordx4 v52, s[28:31], s53 offen sc1 lds
    s_add_u32 m0, s49, 33792
    s_nop 0
    buffer_load_dwordx4 v53, s[28:31], s53 offen sc1 lds
    s_add_u32 m0, s49, 34816
    s_nop 0
    buffer_load_dwordx4 v54, s[28:31], s53 offen sc1 lds
    s_add_u32 m0, s49, 35840
    s_nop 0
    buffer_load_dwordx4 v55, s[28:31], s53 offen sc1 lds
    s_add_u32 s53, s53, 16384
    s_cmp_eq_u32 s53, s6
    s_cselect_b32 s3, 32768, 0
    s_add_u32 s53, s53, s3
    s_waitcnt vmcnt(8)
    s_barrier
    s_add_u32 m0, s49, 49152
    s_nop 0
    buffer_load_dwordx4 v52, s[28:31], s53 offen sc1 lds
    s_add_u32 m0, s49, 50176
    s_nop 0
    buffer_load_dwordx4 v53, s[28:31], s53 offen sc1 lds
    s_add_u32 m0, s49, 51200
    s_nop 0
    buffer_load_dwordx4 v54, s[28:31], s53 offen sc1 lds
    s_add_u32 m0, s49, 52224
    s_nop 0
    buffer_load_dwordx4 v55, s[28:31], s53 offen sc1 lds
    s_add_u32 s53, s53, 16384
    s_cmp_eq_u32 s53, s6
    s_cselect_b32 s3, 32768, 0
    s_add_u32 s53, s53, s3
    s_waitcnt vmcnt(8)
    s_barrier
    s_add_u32 m0, s49, 0
    s_nop 0
    buffer_load_dwordx4 v52, s[28:31], s53 offen sc1 lds
    s_add_u32 m0, s49, 1024
    s_nop 0
    buffer_load_dwordx4 v53, s[28:31], s53 offen sc1 lds
    s_add_u32 m0, s49, 2048
    s_nop 0
    buffer_load_dwordx4 v54, s[28:31], s53 offen sc1 lds
    s_add_u32 m0, s49, 3072
    s_nop 0
    buffer_load_dwordx4 v55, s[28:31], s53 offen sc1 lds
    s_add_u32 s53, s53, 16384
    s_cmp_eq_u32 s53, s6
    s_cselect_b32 s3, 32768, 0
    s_add_u32 s53, s53, s3
    s_waitcnt vmcnt(8)
    s_barrier
    s_add_u32 m0, s49, 16384
    s_nop 0
    buffer_load_dwordx4 v52, s[28:31], s53 offen sc1 lds
    s_add_u32 m0, s49, 17408
    s_nop 0
    buffer_load_dwordx4 v53, s[28:31], s53 offen sc1 lds
    s_add_u32 m0, s49, 18432
    s_nop 0
    buffer_load_dwordx4 v54, s[28:31], s53 offen sc1 lds
    s_add_u32 m0, s49, 19456
    s_nop 0
    buffer_load_dwordx4 v55, s[28:31], s53 offen sc1 lds
    s_add_u32 s53, s53, 16384
    s_cmp_eq_u32 s53, s6
    s_cselect_b32 s3, 32768, 0
    s_add_u32 s53, s53, s3
    s_waitcnt vmcnt(8)
    s_barrier
    s_add_u32 m0, s49, 32768
    s_nop 0
    buffer_load_dwordx4 v52, s[28:31], s53 offen sc1 lds
    s_add_u32 m0, s49, 33792
    s_nop 0
    buffer_load_dwordx4 v53, s[28:31], s53 offen sc1 lds
    s_add_u32 m0, s49, 34816
    s_nop 0
    buffer_load_dwordx4 v54, s[28:31], s53 offen sc1 lds
    s_add_u32 m0, s49, 35840
    s_nop 0
    buffer_load_dwordx4 v55, s[28:31], s53 offen sc1 lds
    s_add_u32 s53, s53, 16384
    s_cmp_eq_u32 s53, s6
    s_cselect_b32 s3, 32768, 0
    s_add_u32 s53, s53, s3
    s_waitcnt vmcnt(8)
    s_barrier
    s_add_u32 m0, s49, 49152
    s_nop 0
    buffer_load_dwordx4 v52, s[28:31], s53 offen sc1 lds
    s_add_u32 m0, s49, 50176
    s_nop 0
    buffer_load_dwordx4 v53, s[28:31], s53 offen sc1 lds
    s_add_u32 m0, s49, 51200
    s_nop 0
    buffer_load_dwordx4 v54, s[28:31], s53 offen sc1 lds
    s_add_u32 m0, s49, 52224
    s_nop 0
    buffer_load_dwordx4 v55, s[28:31], s53 offen sc1 lds
    s_add_u32 s53, s53, 16384
    s_cmp_eq_u32 s53, s6
    s_cselect_b32 s3, 32768, 0
    s_add_u32 s53, s53, s3
    s_waitcnt vmcnt(8)
    s_barrier
    s_add_u32 m0, s49, 0
    s_nop 0
    buffer_load_dwordx4 v52, s[28:31], s53 offen sc1 lds
    s_add_u32 m0, s50, 0
    s_nop 0
    buffer_load_dwordx4 v56, s[20:23], s54 offen sc1 lds
    s_add_u32 m0, s49, 1024
    s_nop 0
    buffer_load_dwordx4 v53, s[28:31], s53 offen sc1 lds
    s_add_u32 m0, s50, 1024
    s_nop 0
    buffer_load_dwordx4 v57, s[20:23], s54 offen sc1 lds
    s_add_u32 m0, s49, 2048
    s_nop 0
    buffer_load_dwordx4 v54, s[28:31], s53 offen sc1 lds
    s_add_u32 m0, s49, 3072
    s_nop 0
    buffer_load_dwordx4 v55, s[28:31], s53 offen sc1 lds
    s_add_u32 s53, s53, 16384
    s_cmp_eq_u32 s53, s6
    s_cselect_b32 s3, 32768, 0
    s_add_u32 s53, s53, s3
    s_add_u32 s54, s54, 8192
    s_cmp_eq_u32 s54, s7
    s_cselect_b32 s3, 16384, 0
    s_add_u32 s54, s54, s3
    s_waitcnt vmcnt(10)
    s_barrier
    s_add_u32 m0, s49, 16384
    s_nop 0
    buffer_load_dwordx4 v52, s[28:31], s53 offen sc1 lds
    s_add_u32 m0, s50, 8192
    s_nop 0
    buffer_load_dwordx4 v56, s[20:23], s54 offen sc1 lds
    s_add_u32 m0, s49, 17408
    s_nop 0
    buffer_load_dwordx4 v53, s[28:31], s53 offen sc1 lds
    s_add_u32 m0, s50, 9216
    s_nop 0
    buffer_load_dwordx4 v57, s[20:23], s54 offen sc1 lds
    s_add_u32 m0, s49, 18432
    s_nop 0
    buffer_load_dwordx4 v54, s[28:31], s53 offen sc1 lds
    s_add_u32 m0, s49, 19456
    s_nop 0
    buffer_load_dwordx4 v55, s[28:31], s53 offen sc1 lds
    s_add_u32 s53, s53, 16384
    s_cmp_eq_u32 s53, s6
    s_cselect_b32 s3, 32768, 0
    s_add_u32 s53, s53, s3
    s_add_u32 s54, s54, 8192
    s_cmp_eq_u32 s54, s7
    s_cselect_b32 s3, 16384, 0
    s_add_u32 s54, s54, s3
    s_waitcnt vmcnt(12)
    s_barrier
    s_add_u32 m0, s49, 32768
    s_nop 0
    buffer_load_dwordx4 v52, s[28:31], s53 offen sc1 lds
    s_add_u32 m0, s50, 16384
    s_nop 0
    buffer_load_dwordx4 v56, s[20:23], s54 offen sc1 lds
    s_add_u32 m0, s49, 33792
    s_nop 0
    buffer_load_dwordx4 v53, s[28:31], s53 offen sc1 lds
    s_add_u32 m0, s50, 17408
    s_nop 0
    buffer_load_dwordx4 v57, s[20:23], s54 offen sc1 lds
    s_add_u32 m0, s49, 34816
    s_nop 0
    buffer_load_dwordx4 v54, s[28:31], s53 offen sc1 lds
    s_add_u32 m0, s49, 35840
    s_nop 0
    buffer_load_dwordx4 v55, s[28:31], s53 offen sc1 lds
    s_add_u32 s53, s53, 16384
    s_cmp_eq_u32 s53, s6
    s_cselect_b32 s3, 32768, 0
    s_add_u32 s53, s53, s3
    s_add_u32 s54, s54, 8192
    s_cmp_eq_u32 s54, s7
    s_cselect_b32 s3, 16384, 0
    s_add_u32 s54, s54, s3
    s_waitcnt vmcnt(12)
    s_barrier
    s_add_u32 m0, s49, 49152
    s_nop 0
    buffer_load_dwordx4 v52, s[28:31], s53 offen sc1 lds
    s_add_u32 m0, s50, 24576
    s_nop 0
    buffer_load_dwordx4 v56, s[20:23], s54 offen sc1 lds
    s_add_u32 m0, s49, 50176
    s_nop 0
    buffer_load_dwordx4 v53, s[28:31], s53 offen sc1 lds
    s_add_u32 m0, s50, 25600
    s_nop 0
    buffer_load_dwordx4 v57, s[20:23], s54 offen sc1 lds
    s_add_u32 m0, s49, 51200
    s_nop 0
    buffer_load_dwordx4 v54, s[28:31], s53 offen sc1 lds
    s_add_u32 m0, s49, 52224
    s_nop 0
    buffer_load_dwordx4 v55, s[28:31], s53 offen sc1 lds
    s_add_u32 s53, s53, 16384
    s_cmp_eq_u32 s53, s6
    s_cselect_b32 s3, 32768, 0
    s_add_u32 s53, s53, s3
    s_add_u32 s54, s54, 8192
    s_cmp_eq_u32 s54, s7
    s_cselect_b32 s3, 16384, 0
    s_add_u32 s54, s54, s3
L_m_pl76:
L_m_g3s0:
    s_waitcnt vmcnt(12)
    s_barrier
    s_add_u32 m0, s49, 0
    s_nop 0
    buffer_load_dwordx4 v52, s[28:31], s53 offen sc1 lds
    s_add_u32 m0, s50, 0
    s_nop 0
    buffer_load_dwordx4 v56, s[20:23], s54 offen sc1 lds
    s_add_u32 m0, s49, 1024
    s_nop 0
    buffer_load_dwordx4 v53, s[28:31], s53 offen sc1 lds
    s_add_u32 m0, s50, 1024
    s_nop 0
    buffer_load_dwordx4 v57, s[20:23], s54 offen sc1 lds
    s_add_u32 m0, s49, 2048
    s_nop 0
    buffer_load_dwordx4 v54, s[28:31], s53 offen sc1 lds
    s_add_u32 m0, s49, 3072
    s_nop 0
    buffer_load_dwordx4 v55, s[28:31], s53 offen sc1 lds
    s_add_u32 s53, s53, 16384
    s_cmp_eq_u32 s53, s6
    s_cselect_b32 s3, 32768, 0
    s_add_u32 s53, s53, s3
    s_add_u32 s54, s54, 8192
    s_cmp_eq_u32 s54, s7
    s_cselect_b32 s3, 16384, 0
    s_add_u32 s54, s54, s3
L_m_g3s1:
    s_waitcnt vmcnt(12)
    s_barrier
    s_add_u32 m0, s49, 16384
    s_nop 0
    buffer_load_dwordx4 v52, s[28:31], s53 offen sc1 lds
    s_add_u32 m0, s50, 8192
    s_nop 0
    buffer_load_dwordx4 v56, s[20:23], s54 offen sc1 lds
    s_add_u32 m0, s49, 17408
    s_nop 0
    buffer_load_dwordx4 v53, s[28:31], s53 offen sc1 lds
    s_add_u32 m0, s50, 9216
    s_nop 0
    buffer_load_dwordx4 v57, s[20:23], s54 offen sc1 lds
    s_add_u32 m0, s49, 18432
    s_nop 0
    buffer_load_dwordx4 v54, s[28:31], s53 offen sc1 lds
    s_add_u32 m0, s49, 19456
    s_nop 0
    buffer_load_dwordx4 v55, s[28:31], s53 offen sc1 lds
    s_add_u32 s53, s53, 16384
    s_cmp_eq_u32 s53, s6
    s_cselect_b32 s3, 32768, 0
    s_add_u32 s53, s53, s3
    s_add_u32 s54, s54, 8192
    s_cmp_eq_u32 s54, s7
    s_cselect_b32 s3, 16384, 0
    s_add_u32 s54, s54, s3
L_m_g3s2:
    s_waitcnt vmcnt(12)
    s_barrier
    s_add_u32 m0, s49, 32768
    s_nop 0
    buffer_load_dwordx4 v52, s[28:31], s53 offen sc1 lds
    s_add_u32 m0, s50, 16384
    s_nop 0
    buffer_load_dwordx4 v56, s[20:23], s54 offen sc1 lds
    s_add_u32 m0, s49, 33792
    s_nop 0
    buffer_load_dwordx4 v53, s[28:31], s53 offen sc1 lds
    s_add_u32 m0, s50, 17408
    s_nop 0
    buffer_load_dwordx4 v57, s[20:23], s54 offen sc1 lds
    s_add_u32 m0, s49, 34816
    s_nop 0
    buffer_load_dwordx4 v54, s[28:31], s53 offen sc1 lds
    s_add_u32 m0, s49, 35840
    s_nop 0
    buffer_load_dwordx4 v55, s[28:31], s53 offen sc1 lds
    s_add_u32 s53, s53, 16384
    s_cmp_eq_u32 s53, s6
    s_cselect_b32 s3, 32768, 0
    s_add_u32 s53, s53, s3
    s_add_u32 s54, s54, 8192
    s_cmp_eq_u32 s54, s7
    s_cselect_b32 s3, 16384, 0
    s_add_u32 s54, s54, s3
L_m_g3s3:
    s_waitcnt vmcnt(12)
    s_barrier
    s_add_u32 m0, s49, 49152
    s_nop 0
    buffer_load_dwordx4 v52, s[28:31], s53 offen sc1 lds
    s_add_u32 m0, s50, 24576
    s_nop 0
    buffer_load_dwordx4 v56, s[20:23], s54 offen sc1 lds
    s_add_u32 m0, s49, 50176
    s_nop 0
    buffer_load_dwordx4 v53, s[28:31], s53 offen sc1 lds
    s_add_u32 m0, s50, 25600
    s_nop 0
    buffer_load_dwordx4 v57, s[20:23], s54 offen sc1 lds
    s_add_u32 m0, s49, 51200
    s_nop 0
    buffer_load_dwordx4 v54, s[28:31], s53 offen sc1 lds
    s_add_u32 m0, s49, 52224
    s_nop 0
    buffer_load_dwordx4 v55, s[28:31], s53 offen sc1 lds
    s_add_u32 s53, s53, 16384
    s_cmp_eq_u32 s53, s6
    s_cselect_b32 s3, 32768, 0
    s_add_u32 s53, s53, s3
    s_add_u32 s54, s54, 8192
    s_cmp_eq_u32 s54, s7
    s_cselect_b32 s3, 16384, 0
    s_add_u32 s54, s54, s3
    s_sub_u32 s63, s63, 1
    s_cmp_lg_u32 s63, 0
    s_cbranch_scc1 L_m_pl76
    s_waitcnt vmcnt(12)
    s_barrier
    buffer_load_dwordx4 v[124:127], v120, s[32:35], 0 offen sc1
    buffer_load_dwordx4 v[128:131], v120, s[32:35], s9 offen sc1
    buffer_load_dwordx4 v[132:135], v121, s[36:39], 0 offen sc1
    s_waitcnt vmcnt(9)
    s_barrier
    s_waitcnt vmcnt(3)
    s_barrier
    s_barrier
L_m_fin:
    s_waitcnt vmcnt(0) lgkmcnt(0)
    s_barrier
    v_add_u32 v122, 65536, v122
    ds_read_b128 v[48:51], v122 offset:0
    ds_read_b128 v[52:55], v122 offset:8192
    v_lshlrev_b32 v96, 16, v132
    v_and_b32 v97, 0xffff0000, v132
    v_lshlrev_b32 v98, 16, v133
    v_and_b32 v99, 0xffff0000, v133
    v_lshlrev_b32 v100, 16, v134
    v_and_b32 v101, 0xffff0000, v134
    v_lshlrev_b32 v102, 16, v135
    v_and_b32 v103, 0xffff0000, v135
    v_lshlrev_b32 v72, 16, v124
    v_and_b32 v73, 0xffff0000, v124
    v_lshlrev_b32 v74, 16, v125
    v_and_b32 v75, 0xffff0000, v125
    v_lshlrev_b32 v76, 16, v126
    v_and_b32 v77, 0xffff0000, v126
    v_lshlrev_b32 v78, 16, v127
    v_and_b32 v79, 0xffff0000, v127
    v_lshlrev_b32 v88, 16, v128
    v_and_b32 v89, 0xffff0000, v128
    v_lshlrev_b32 v90, 16, v129
    v_and_b32 v91, 0xffff0000, v129
    v_lshlrev_b32 v92, 16, v130
    v_and_b32 v93, 0xffff0000, v130
    v_lshlrev_b32 v94, 16, v131
    v_and_b32 v95, 0xffff0000, v131
    s_waitcnt lgkmcnt(1)
    v_lshlrev_b32 v64, 16, v48
    v_and_b32 v65, 0xffff0000, v48
    v_lshlrev_b32 v66, 16, v49
    v_and_b32 v67, 0xffff0000, v49
    v_lshlrev_b32 v68, 16, v50
    v_and_b32 v69, 0xffff0000, v50
    v_lshlrev_b32 v70, 16, v51
    v_and_b32 v71, 0xffff0000, v51
    v_pk_fma_f32 v[64:65], v[64:65], v[96:97], v[72:73]
    v_pk_fma_f32 v[66:67], v[66:67], v[98:99], v[74:75]
    v_pk_fma_f32 v[68:69], v[68:69], v[100:101], v[76:77]
    v_pk_fma_f32 v[70:71], v[70:71], v[102:103], v[78:79]
    v_cvt_pk_bf16_f32 v56, v64, v65
    v_cvt_pk_bf16_f32 v57, v66, v67
    v_cvt_pk_bf16_f32 v58, v68, v69
    v_cvt_pk_bf16_f32 v59, v70, v71
    buffer_store_dwordx4 v[56:59], v120, s[24:27], 0 offen
    s_waitcnt lgkmcnt(0)
    v_lshlrev_b32 v80, 16, v52
    v_and_b32 v81, 0xffff0000, v52
    v_lshlrev_b32 v82, 16, v53
    v_and_b32 v83, 0xffff0000, v53
    v_lshlrev_b32 v84, 16, v54
    v_and_b32 v85, 0xffff0000, v54
    v_lshlrev_b32 v86, 16, v55
    v_and_b32 v87, 0xffff0000, v55
    v_pk_fma_f32 v[80:81], v[80:81], v[96:97], v[88:89]
    v_pk_fma_f32 v[82:83], v[82:83], v[98:99], v[90:91]
    v_pk_fma_f32 v[84:85], v[84:85], v[100:101], v[92:93]
    v_pk_fma_f32 v[86:87], v[86:87], v[102:103], v[94:95]
    v_cvt_pk_bf16_f32 v60, v80, v81
    v_cvt_pk_bf16_f32 v61, v82, v83
    v_cvt_pk_bf16_f32 v62, v84, v85
    v_cvt_pk_bf16_f32 v63, v86, v87
    buffer_store_dwordx4 v[60:63], v120, s[24:27], s9 offen
L_m_end:
    s_endpgm
.section .rodata,"a"
.p2align 6
.amdhsa_kernel adaLN_cond__ssm_conv_h3__mixer_gmlp__prompt_kernel
  .amdhsa_next_free_vgpr 256
  .amdhsa_next_free_sgpr 102
  .amdhsa_accum_offset 256
  .amdhsa_group_segment_fixed_size 0
  .amdhsa_kernarg_size 128
  .amdhsa_user_sgpr_count 2
  .amdhsa_user_sgpr_kernarg_segment_ptr 1
  .amdhsa_system_sgpr_workgroup_id_x 1
  .amdhsa_float_denorm_mode_32 3
.end_amdhsa_kernel
```
